```python
import torch

def _softmax(x, axis=-1):
    return torch.softmax(x, dim=axis)
def _gelu(x):
    return torch.nn.functional.gelu(x, approximate="tanh")
def _silu(x):
    return torch.nn.functional.silu(x)
def _sigmoid(x):
    return torch.sigmoid(x)
def _layernorm(x, axis=-1, eps=1e-5):
    m = x.mean(dim=axis, keepdim=True)
    v = x.var(dim=axis, keepdim=True, unbiased=False)
    return (x - m) / torch.sqrt(v + eps)
def _scatter_add(tgt, idx, src, axis=0):
    return tgt.clone().index_add_(axis, idx, src)
def _segment_sum(src, seg, n):
    out = torch.zeros((n,) + src.shape[1:], dtype=src.dtype)
    return out.index_add_(0, seg, src)
def _pad(x, pw):
    flat = tuple(v for pair in reversed(pw) for v in pair)
    return torch.nn.functional.pad(x, flat)

kernel_name = 'gated_mix__mha_block_cached__dense_activation_gelu__decode'

def setup_inputs():

    _w = (lambda a: (lambda t: t.to(torch.bfloat16) if t.is_floating_point() else t)(torch.as_tensor(a)))
    def _A_setup():
        B, Sq, D = 2, 1, 448
        H, Sk, Dh = 16, 4096, 256
        return {
            "x": _w((lambda *s: torch.randn(*s, dtype=torch.bfloat16) * 0.05)(B, Sq, D)),
            "k_cache": _w((lambda *s: torch.randn(*s, dtype=torch.bfloat16) * 6.4)(B, H, Sk, Dh)),
            "v_cache": _w((lambda *s: torch.randn(*s, dtype=torch.bfloat16) * 0.4)(B, H, Sk, Dh)),
            "wq": _w((lambda *s: torch.randn(*s, dtype=torch.bfloat16) * 6.4)(D, H * Dh) * (D ** -0.5)),
            "wo": _w((lambda *s: torch.randn(*s, dtype=torch.bfloat16) * 0.4)(H * Dh, D) * ((H * Dh) ** -0.5)),
        }
    _A_in = _A_setup()

    def _B_setup():
        B, S, D, F = 2, 1, 448, 1792
        return {
            "x": _w((lambda *s: torch.randn(*s, dtype=torch.bfloat16) * 0.05)(B, S, D)),
            "w1": _w((lambda *s: torch.randn(*s, dtype=torch.bfloat16) * 3.2)(D, F) * (D ** -0.5)),
            "b1": _w((lambda *s: torch.randn(*s, dtype=torch.bfloat16) * 3.2)(F) * 0.01),
            "w2": _w((lambda *s: torch.randn(*s, dtype=torch.bfloat16) * 0.4)(F, D) * (F ** -0.5)),
            "b2": _w((lambda *s: torch.randn(*s, dtype=torch.bfloat16) * 0.8)(D) * 0.01),
        }
    _B_in = _B_setup()

    return {
        "A_x": _A_in["x"],
        "A_k_cache": _A_in["k_cache"],
        "A_v_cache": _A_in["v_cache"],
        "A_wq": _A_in["wq"],
        "A_wo": _A_in["wo"],
        "B_x": _B_in["x"],
        "B_w1": _B_in["w1"],
        "B_b1": _B_in["b1"],
        "B_w2": _B_in["w2"],
        "B_b2": _B_in["b2"],
        "gate_w": _w((lambda *s: torch.randn(*s, dtype=torch.bfloat16) * 0.1)(448) * 16.0),
    }

def reference(A_x, A_k_cache, A_v_cache, A_wq, A_wo, B_x, B_w1, B_b1, B_w2, B_b2, gate_w):
    def _A_ref(x, k_cache, v_cache, wq, wo):
        B, Sq, D = x.shape
        H, Dh = 16, 256
        q = (lambda x, *d: x.permute(*d))((x @ wq).reshape(B, Sq, H, Dh), 0, 2, 1, 3)
        scores = torch.einsum("bhqd,bhkd->bhqk", q, k_cache) * (Dh ** -0.5)
        p = _softmax(scores, axis=-1)
        o = torch.einsum("bhqk,bhkd->bhqd", p, v_cache)
        return (lambda x, *d: x.permute(*d))(o, 0, 2, 1, 3).reshape(B, Sq, H * Dh) @ wo

    def _B_ref(x, w1, b1, w2, b2):
        h = torch.einsum("bsd,df->bsf", x, w1) + b1
        h = _gelu(h)
        return torch.einsum("bsf,fd->bsd", h, w2) + b2

    x = A_x
    g = _sigmoid((x * gate_w).sum(-1, keepdims=True))
    a = _A_ref(x, A_k_cache, A_v_cache, A_wq, A_wo)
    b = _B_ref(x, B_w1, B_b1, B_w2, B_b2)
    return g * a + (1 - g) * b
```

```asm
; @launch grid=(256,1,1) block=(512,1,1) lds=9216
.amdgcn_target "amdgcn-amd-amdhsa--gfx950"
.text
.globl gated_mix__mha_block_cached__dense_activation_gelu__decode_kernel
.p2align 8
.type gated_mix__mha_block_cached__dense_activation_gelu__decode_kernel,@function
gated_mix__mha_block_cached__dense_activation_gelu__decode_kernel:
    s_cmp_ge_u32 s2, 256
    s_cbranch_scc1 L_END
    s_load_dwordx16 s[16:31], s[0:1], 0
    s_load_dwordx8 s[32:39], s[0:1], 64
    s_load_dwordx4 s[40:43], s[0:1], 96
    v_lshrrev_b32 v13, 6, v0
    v_and_b32 v0, 63, v0
    v_readfirstlane_b32 s7, v13
    s_and_b32 s3, s2, 7
    s_lshr_b32 s9, s2, 3
    s_and_b32 s10, s9, 1
    s_lshl_b32 s11, s10, 3
    s_add_u32 s4, s11, s3
    s_lshr_b32 s5, s9, 1
    s_and_b32 s5, s5, 1
    s_lshr_b32 s6, s9, 2
    s_lshl_b32 s14, s5, 4
    s_add_u32 s14, s14, s4
    s_mov_b32 s60, s5
    s_mov_b32 s61, s4
    s_lshl_b32 s8, s6, 4
    s_add_u32 s8, s8, s61
    v_lshlrev_b32 v1, 4, v0
    s_mov_b32 s84, 0x05040100
    s_mov_b32 s85, 0x07060302
    s_cmp_eq_u32 s7, 0
    s_cbranch_scc1 L_QWAVE
    s_cmp_eq_u32 s7, 1
    s_cselect_b32 s94, s60, 0
    s_cmp_lt_u32 s8, 112
    s_cselect_b32 s94, s94, 0
    s_cmp_eq_u32 s94, 1
    s_cbranch_scc1 L_HWAVE
    s_lshl_b32 s94, s14, 21
    s_lshl_b32 s95, s6, 18
    s_add_u32 s94, s94, s95
    s_mul_i32 s95, s7, 4096
    s_add_u32 s94, s94, s95
    s_mov_b32 s86, 32768
    s_mov_b32 s87, 65536
    s_mov_b32 s88, 98304
    s_mov_b32 s89, 131072
    s_mov_b32 s90, 163840
    s_mov_b32 s91, 196608
    s_mov_b32 s92, 229376
    s_waitcnt lgkmcnt(0)
    s_add_u32 s44, s18, s94
    s_addc_u32 s45, s19, 0
    s_mov_b32 s46, 233472
    s_mov_b32 s47, 0x00020000
    s_add_u32 s48, s20, s94
    s_addc_u32 s49, s21, 0
    s_mov_b32 s50, 233472
    s_mov_b32 s51, 0x00020000
    buffer_load_dwordx4 v[64:67], v1, s[44:47], 0 offen offset:0 nt
    buffer_load_dwordx4 v[68:71], v1, s[44:47], 0 offen offset:1024 nt
    buffer_load_dwordx4 v[72:75], v1, s[44:47], 0 offen offset:2048 nt
    s_waitcnt vmcnt(2)
    buffer_load_dwordx4 v[76:79], v1, s[44:47], 0 offen offset:3072 nt
    s_waitcnt vmcnt(2)
    buffer_load_dwordx4 v[80:83], v1, s[44:47], s86 offen offset:0 nt
    s_waitcnt vmcnt(2)
    buffer_load_dwordx4 v[84:87], v1, s[44:47], s86 offen offset:1024 nt
    s_waitcnt vmcnt(2)
    buffer_load_dwordx4 v[88:91], v1, s[44:47], s86 offen offset:2048 nt
    s_waitcnt vmcnt(2)
    buffer_load_dwordx4 v[92:95], v1, s[44:47], s86 offen offset:3072 nt
    s_lshl_b32 s94, s4, 3
    s_add_u32 s95, s94, s7
    s_lshl_b32 s95, s95, 12
    s_lshl_b32 s9, s5, 3
    s_add_u32 s9, s9, s6
    s_lshl_b32 s93, s9, 7
    s_add_u32 s93, s93, s95
    v_lshrrev_b32 v13, 3, v0
    v_and_b32 v14, 7, v0
    v_lshl_add_u32 v3, v13, 4, s93
    s_lshl_b32 s93, s9, 3
    s_add_u32 s93, s93, s95
    s_add_u32 s93, s93, 2048
    v_mov_b32 v4, s93
    s_lshl_b32 s95, s61, 3
    s_add_u32 s95, s95, s6
    s_lshl_b32 s95, s95, 12
    v_lshlrev_b32 v6, 7, v14
    v_lshl_add_u32 v6, v13, 4, v6
    v_add_u32 v6, s95, v6
    s_add_u32 s95, s95, 2048
    v_lshl_add_u32 v7, v14, 3, s95
    v_mul_u32_u24 v12, 1040, v14
    v_lshl_add_u32 v12, v13, 4, v12
    s_lshl_b32 s94, s7, 7
    s_add_u32 s94, s94, 0
    v_add_u32 v12, s94, v12
    v_lshrrev_b32 v13, 5, v0
    v_and_b32 v15, 31, v0
    v_lshlrev_b32 v13, 4, v13
    v_lshl_add_u32 v13, v15, 5, v13
    s_mul_i32 s94, s7, 1040
    s_add_u32 s94, s94, 0
    v_add_u32 v10, s94, v13
    s_mul_i32 s94, s60, 524288
    s_add_u32 s94, s94, 524288
    s_lshl_b32 s95, s7, 15
    s_add_u32 s95, s95, s94
    s_lshl_b32 s93, s8, 6
    s_add_u32 s95, s95, s93
    v_lshrrev_b32 v15, 1, v14
    v_lshlrev_b32 v5, 13, v15
    v_and_b32 v15, 1, v0
    v_lshl_add_u32 v5, v15, 5, v5
    v_lshrrev_b32 v15, 5, v0
    v_lshl_add_u32 v5, v15, 18, v5
    v_bfe_u32 v15, v0, 4, 1
    v_lshl_add_u32 v5, v15, 4, v5
    v_add_u32 v5, s95, v5
    s_cmp_ge_u32 s8, 28
    s_cselect_b32 s13, 1, 0
    s_mul_i32 s94, s13, 28
    s_sub_u32 s12, s8, s94
    s_min_u32 s12, s12, 27
    s_lshl_b32 s94, s13, 18
    s_add_u32 s94, s94, 524288
    s_lshl_b32 s95, s12, 13
    s_add_u32 s95, s95, s94
    v_and_b32 v15, 15, v0
    v_lshlrev_b32 v8, 6, v15
    v_lshrrev_b32 v15, 4, v0
    v_lshl_add_u32 v8, v15, 4, v8
    v_add_u32 v8, s95, v8
    s_mov_b32 s96, 0xcccccccc
    s_mov_b32 s97, 0xcccccccc
    s_mov_b32 s98, 0xaaaaaaaa
    s_mov_b32 s99, 0xaaaaaaaa
    s_waitcnt vmcnt(2)
    buffer_load_dwordx4 v[96:99], v1, s[44:47], s87 offen offset:0 nt
    s_waitcnt vmcnt(2)
    buffer_load_dwordx4 v[100:103], v1, s[44:47], s87 offen offset:1024 nt
    s_waitcnt vmcnt(2)
    buffer_load_dwordx4 v[104:107], v1, s[44:47], s87 offen offset:2048 nt
    s_waitcnt vmcnt(2)
    buffer_load_dwordx4 v[108:111], v1, s[44:47], s87 offen offset:3072 nt
    s_waitcnt vmcnt(2)
    buffer_load_dwordx4 v[112:115], v1, s[44:47], s88 offen offset:0 nt
    s_waitcnt vmcnt(2)
    buffer_load_dwordx4 v[116:119], v1, s[44:47], s88 offen offset:1024 nt
    s_waitcnt vmcnt(2)
    buffer_load_dwordx4 v[120:123], v1, s[44:47], s88 offen offset:2048 nt
    s_waitcnt vmcnt(2)
    buffer_load_dwordx4 v[124:127], v1, s[44:47], s88 offen offset:3072 nt
    s_waitcnt vmcnt(2)
    buffer_load_dwordx4 v[128:131], v1, s[44:47], s89 offen offset:0 nt
    s_waitcnt vmcnt(2)
    buffer_load_dwordx4 v[132:135], v1, s[44:47], s89 offen offset:1024 nt
    s_waitcnt vmcnt(2)
    buffer_load_dwordx4 v[136:139], v1, s[44:47], s89 offen offset:2048 nt
    s_waitcnt vmcnt(2)
    buffer_load_dwordx4 v[140:143], v1, s[44:47], s89 offen offset:3072 nt
    s_waitcnt vmcnt(2)
    buffer_load_dwordx4 v[144:147], v1, s[44:47], s90 offen offset:0 nt
    s_waitcnt vmcnt(2)
    buffer_load_dwordx4 v[148:151], v1, s[44:47], s90 offen offset:1024 nt
    s_waitcnt vmcnt(2)
    buffer_load_dwordx4 v[152:155], v1, s[44:47], s90 offen offset:2048 nt
    s_waitcnt vmcnt(2)
    buffer_load_dwordx4 v[156:159], v1, s[44:47], s90 offen offset:3072 nt
    s_waitcnt vmcnt(2)
    buffer_load_dwordx4 v[160:163], v1, s[44:47], s91 offen offset:0 nt
    s_waitcnt vmcnt(2)
    buffer_load_dwordx4 v[164:167], v1, s[44:47], s91 offen offset:1024 nt
    s_waitcnt vmcnt(2)
    buffer_load_dwordx4 v[168:171], v1, s[44:47], s91 offen offset:2048 nt
    s_waitcnt vmcnt(2)
    buffer_load_dwordx4 v[172:175], v1, s[44:47], s91 offen offset:3072 nt
    s_waitcnt vmcnt(2)
    buffer_load_dwordx4 v[176:179], v1, s[44:47], s92 offen offset:0 nt
    s_waitcnt vmcnt(2)
    buffer_load_dwordx4 v[180:183], v1, s[44:47], s92 offen offset:1024 nt
    s_waitcnt vmcnt(2)
    buffer_load_dwordx4 v[184:187], v1, s[44:47], s92 offen offset:2048 nt
    s_waitcnt vmcnt(2)
    buffer_load_dwordx4 v[188:191], v1, s[44:47], s92 offen offset:3072 nt
    s_waitcnt vmcnt(2)
    buffer_load_dwordx4 v[192:195], v1, s[48:51], 0 offen offset:0 nt
    s_waitcnt vmcnt(2)
    buffer_load_dwordx4 v[196:199], v1, s[48:51], 0 offen offset:1024 nt
    s_waitcnt vmcnt(2)
    buffer_load_dwordx4 v[200:203], v1, s[48:51], 0 offen offset:2048 nt
    s_waitcnt vmcnt(2)
    buffer_load_dwordx4 v[204:207], v1, s[48:51], 0 offen offset:3072 nt
    s_branch L_B1
L_HWAVE:
    s_setprio 3
    s_mul_i32 s11, s8, 147
    s_lshr_b32 s11, s11, 12
    s_mul_i32 s95, s11, 28
    s_sub_u32 s10, s8, s95
    v_lshrrev_b32 v13, 3, v0
    v_and_b32 v14, 7, v0
    s_mul_i32 s95, s11, 401408
    s_lshl_b32 s93, s10, 7
    s_add_u32 s95, s95, s93
    v_mul_u32_u24 v11, 50176, v13
    v_lshl_add_u32 v11, v14, 4, v11
    v_mul_u32_u24 v15, 28, v13
    s_mul_i32 s94, s11, 224
    s_waitcnt lgkmcnt(0)
    s_add_u32 s52, s28, s95
    s_addc_u32 s53, s29, 0
    s_mov_b32 s54, 397952
    s_mov_b32 s55, 0x00020000
    buffer_load_dwordx4 v[192:195], v11, s[52:55], 0 offen nt
    s_mov_b32 s93, 3584
    buffer_load_dwordx4 v[196:199], v11, s[52:55], s93 offen nt
    s_mov_b32 s93, 7168
    buffer_load_dwordx4 v[200:203], v11, s[52:55], s93 offen nt
    s_mov_b32 s93, 10752
    buffer_load_dwordx4 v[204:207], v11, s[52:55], s93 offen nt
    s_mov_b32 s93, 14336
    buffer_load_dwordx4 v[208:211], v11, s[52:55], s93 offen nt
    s_mov_b32 s93, 17920
    buffer_load_dwordx4 v[212:215], v11, s[52:55], s93 offen nt
    s_mov_b32 s93, 21504
    buffer_load_dwordx4 v[216:219], v11, s[52:55], s93 offen nt
    s_mov_b32 s93, 25088
    buffer_load_dwordx4 v[220:223], v11, s[52:55], s93 offen nt
    s_mov_b32 s93, 28672
    buffer_load_dwordx4 v[224:227], v11, s[52:55], s93 offen nt
    s_mov_b32 s93, 32256
    buffer_load_dwordx4 v[228:231], v11, s[52:55], s93 offen nt
    s_mov_b32 s93, 35840
    buffer_load_dwordx4 v[232:235], v11, s[52:55], s93 offen nt
    s_mov_b32 s93, 39424
    buffer_load_dwordx4 v[236:239], v11, s[52:55], s93 offen nt
    s_mov_b32 s93, 43008
    buffer_load_dwordx4 v[240:243], v11, s[52:55], s93 offen nt
    s_mov_b32 s93, 46592
    buffer_load_dwordx4 v[244:247], v11, s[52:55], s93 offen nt
    s_mov_b32 s56, s16
    s_mov_b32 s57, s17
    s_mov_b32 s58, 1792
    s_mov_b32 s59, 0x00020000
    buffer_load_dwordx4 v[16:19], v15, s[56:59], s94 offen nt
    buffer_load_dwordx3 v[20:22], v15, s[56:59], s94 offen offset:16 nt
    buffer_load_dwordx4 v[24:27], v15, s[56:59], s94 offen offset:896 nt
    buffer_load_dwordx3 v[28:30], v15, s[56:59], s94 offen offset:912 nt
    s_lshl_b32 s95, s10, 11
    s_lshl_b32 s93, s11, 9
    s_add_u32 s95, s95, s93
    s_add_u32 s95, s95, 1703936
    v_lshlrev_b32 v2, 5, v14
    v_bfe_u32 v15, v0, 4, 1
    v_lshl_add_u32 v2, v15, 4, v2
    v_lshrrev_b32 v15, 5, v0
    v_lshl_add_u32 v2, v15, 8, v2
    v_add_u32 v2, s95, v2
    s_lshl_b32 s95, s10, 2
    s_add_u32 s95, s95, 0
    v_mov_b32 v9, s95
    s_lshl_b32 s94, s14, 21
    s_lshl_b32 s95, s6, 18
    s_add_u32 s94, s94, s95
    s_mul_i32 s95, s7, 4096
    s_add_u32 s94, s94, s95
    s_mov_b32 s86, 32768
    s_mov_b32 s87, 65536
    s_mov_b32 s88, 98304
    s_mov_b32 s89, 131072
    s_mov_b32 s90, 163840
    s_mov_b32 s91, 196608
    s_mov_b32 s92, 229376
    s_add_u32 s44, s18, s94
    s_addc_u32 s45, s19, 0
    s_mov_b32 s46, 233472
    s_mov_b32 s47, 0x00020000
    s_add_u32 s48, s20, s94
    s_addc_u32 s49, s21, 0
    s_mov_b32 s50, 233472
    s_mov_b32 s51, 0x00020000
    buffer_load_dwordx4 v[64:67], v1, s[44:47], 0 offen offset:0 nt
    buffer_load_dwordx4 v[68:71], v1, s[44:47], 0 offen offset:1024 nt
    buffer_load_dwordx4 v[72:75], v1, s[44:47], 0 offen offset:2048 nt
    buffer_load_dwordx4 v[76:79], v1, s[44:47], 0 offen offset:3072 nt
    buffer_load_dwordx4 v[80:83], v1, s[44:47], s86 offen offset:0 nt
    buffer_load_dwordx4 v[84:87], v1, s[44:47], s86 offen offset:1024 nt
    s_lshl_b32 s94, s4, 3
    s_add_u32 s95, s94, s7
    s_lshl_b32 s95, s95, 12
    s_lshl_b32 s9, s5, 3
    s_add_u32 s9, s9, s6
    s_lshl_b32 s93, s9, 7
    s_add_u32 s93, s93, s95
    v_lshrrev_b32 v13, 3, v0
    v_and_b32 v14, 7, v0
    v_lshl_add_u32 v3, v13, 4, s93
    s_lshl_b32 s93, s9, 3
    s_add_u32 s93, s93, s95
    s_add_u32 s93, s93, 2048
    v_mov_b32 v4, s93
    s_lshl_b32 s95, s61, 3
    s_add_u32 s95, s95, s6
    s_lshl_b32 s95, s95, 12
    v_lshlrev_b32 v6, 7, v14
    v_lshl_add_u32 v6, v13, 4, v6
    v_add_u32 v6, s95, v6
    s_add_u32 s95, s95, 2048
    v_lshl_add_u32 v7, v14, 3, s95
    v_mul_u32_u24 v12, 1040, v14
    v_lshl_add_u32 v12, v13, 4, v12
    s_lshl_b32 s94, s7, 7
    s_add_u32 s94, s94, 0
    v_add_u32 v12, s94, v12
    v_lshrrev_b32 v13, 5, v0
    v_and_b32 v15, 31, v0
    v_lshlrev_b32 v13, 4, v13
    v_lshl_add_u32 v13, v15, 5, v13
    s_mul_i32 s94, s7, 1040
    s_add_u32 s94, s94, 0
    v_add_u32 v10, s94, v13
    s_mul_i32 s94, s60, 524288
    s_add_u32 s94, s94, 524288
    s_lshl_b32 s95, s7, 15
    s_add_u32 s95, s95, s94
    s_lshl_b32 s93, s8, 6
    s_add_u32 s95, s95, s93
    v_lshrrev_b32 v15, 1, v14
    v_lshlrev_b32 v5, 13, v15
    v_and_b32 v15, 1, v0
    v_lshl_add_u32 v5, v15, 5, v5
    v_lshrrev_b32 v15, 5, v0
    v_lshl_add_u32 v5, v15, 18, v5
    v_bfe_u32 v15, v0, 4, 1
    v_lshl_add_u32 v5, v15, 4, v5
    v_add_u32 v5, s95, v5
    s_cmp_ge_u32 s8, 28
    s_cselect_b32 s13, 1, 0
    s_mul_i32 s94, s13, 28
    s_sub_u32 s12, s8, s94
    s_min_u32 s12, s12, 27
    s_lshl_b32 s94, s13, 18
    s_add_u32 s94, s94, 524288
    s_lshl_b32 s95, s12, 13
    s_add_u32 s95, s95, s94
    v_and_b32 v15, 15, v0
    v_lshlrev_b32 v8, 6, v15
    v_lshrrev_b32 v15, 4, v0
    v_lshl_add_u32 v8, v15, 4, v8
    v_add_u32 v8, s95, v8
    s_mov_b32 s96, 0xcccccccc
    s_mov_b32 s97, 0xcccccccc
    s_mov_b32 s98, 0xaaaaaaaa
    s_mov_b32 s99, 0xaaaaaaaa
    s_waitcnt vmcnt(22)
    v_perm_b32 v48, v196, v192, s84
    v_perm_b32 v49, v196, v192, s85
    v_perm_b32 v50, v197, v193, s84
    v_perm_b32 v51, v197, v193, s85
    v_perm_b32 v52, v198, v194, s84
    v_perm_b32 v53, v198, v194, s85
    v_perm_b32 v54, v199, v195, s84
    v_perm_b32 v55, v199, v195, s85
    s_waitcnt vmcnt(9)
    v_dot2_f32_bf16 v32, v48, v16, 0
    v_dot2_f32_bf16 v33, v49, v16, 0
    v_dot2_f32_bf16 v34, v50, v16, 0
    v_dot2_f32_bf16 v35, v51, v16, 0
    v_dot2_f32_bf16 v36, v52, v16, 0
    v_dot2_f32_bf16 v37, v53, v16, 0
    v_dot2_f32_bf16 v38, v54, v16, 0
    v_dot2_f32_bf16 v39, v55, v16, 0
    s_waitcnt vmcnt(7)
    v_dot2_f32_bf16 v40, v48, v24, 0
    v_dot2_f32_bf16 v41, v49, v24, 0
    v_dot2_f32_bf16 v42, v50, v24, 0
    v_dot2_f32_bf16 v43, v51, v24, 0
    v_dot2_f32_bf16 v44, v52, v24, 0
    v_dot2_f32_bf16 v45, v53, v24, 0
    v_dot2_f32_bf16 v46, v54, v24, 0
    v_dot2_f32_bf16 v47, v55, v24, 0
    v_perm_b32 v48, v204, v200, s84
    v_perm_b32 v49, v204, v200, s85
    v_perm_b32 v50, v205, v201, s84
    v_perm_b32 v51, v205, v201, s85
    v_perm_b32 v52, v206, v202, s84
    v_perm_b32 v53, v206, v202, s85
    v_perm_b32 v54, v207, v203, s84
    v_perm_b32 v55, v207, v203, s85
    v_dot2_f32_bf16 v32, v48, v17, v32
    v_dot2_f32_bf16 v33, v49, v17, v33
    v_dot2_f32_bf16 v34, v50, v17, v34
    v_dot2_f32_bf16 v35, v51, v17, v35
    v_dot2_f32_bf16 v36, v52, v17, v36
    v_dot2_f32_bf16 v37, v53, v17, v37
    v_dot2_f32_bf16 v38, v54, v17, v38
    v_dot2_f32_bf16 v39, v55, v17, v39
    v_dot2_f32_bf16 v40, v48, v25, v40
    v_dot2_f32_bf16 v41, v49, v25, v41
    v_dot2_f32_bf16 v42, v50, v25, v42
    v_dot2_f32_bf16 v43, v51, v25, v43
    v_dot2_f32_bf16 v44, v52, v25, v44
    v_dot2_f32_bf16 v45, v53, v25, v45
    v_dot2_f32_bf16 v46, v54, v25, v46
    v_dot2_f32_bf16 v47, v55, v25, v47
    v_perm_b32 v48, v212, v208, s84
    v_perm_b32 v49, v212, v208, s85
    v_perm_b32 v50, v213, v209, s84
    v_perm_b32 v51, v213, v209, s85
    v_perm_b32 v52, v214, v210, s84
    v_perm_b32 v53, v214, v210, s85
    v_perm_b32 v54, v215, v211, s84
    v_perm_b32 v55, v215, v211, s85
    v_dot2_f32_bf16 v32, v48, v18, v32
    v_dot2_f32_bf16 v33, v49, v18, v33
    v_dot2_f32_bf16 v34, v50, v18, v34
    v_dot2_f32_bf16 v35, v51, v18, v35
    v_dot2_f32_bf16 v36, v52, v18, v36
    v_dot2_f32_bf16 v37, v53, v18, v37
    v_dot2_f32_bf16 v38, v54, v18, v38
    v_dot2_f32_bf16 v39, v55, v18, v39
    v_dot2_f32_bf16 v40, v48, v26, v40
    v_dot2_f32_bf16 v41, v49, v26, v41
    v_dot2_f32_bf16 v42, v50, v26, v42
    v_dot2_f32_bf16 v43, v51, v26, v43
    v_dot2_f32_bf16 v44, v52, v26, v44
    v_dot2_f32_bf16 v45, v53, v26, v45
    v_dot2_f32_bf16 v46, v54, v26, v46
    v_dot2_f32_bf16 v47, v55, v26, v47
    v_perm_b32 v48, v220, v216, s84
    v_perm_b32 v49, v220, v216, s85
    v_perm_b32 v50, v221, v217, s84
    v_perm_b32 v51, v221, v217, s85
    v_perm_b32 v52, v222, v218, s84
    v_perm_b32 v53, v222, v218, s85
    v_perm_b32 v54, v223, v219, s84
    v_perm_b32 v55, v223, v219, s85
    v_dot2_f32_bf16 v32, v48, v19, v32
    v_dot2_f32_bf16 v33, v49, v19, v33
    v_dot2_f32_bf16 v34, v50, v19, v34
    v_dot2_f32_bf16 v35, v51, v19, v35
    v_dot2_f32_bf16 v36, v52, v19, v36
    v_dot2_f32_bf16 v37, v53, v19, v37
    v_dot2_f32_bf16 v38, v54, v19, v38
    v_dot2_f32_bf16 v39, v55, v19, v39
    v_dot2_f32_bf16 v40, v48, v27, v40
    v_dot2_f32_bf16 v41, v49, v27, v41
    v_dot2_f32_bf16 v42, v50, v27, v42
    v_dot2_f32_bf16 v43, v51, v27, v43
    v_dot2_f32_bf16 v44, v52, v27, v44
    v_dot2_f32_bf16 v45, v53, v27, v45
    v_dot2_f32_bf16 v46, v54, v27, v46
    v_dot2_f32_bf16 v47, v55, v27, v47
    v_perm_b32 v48, v228, v224, s84
    v_perm_b32 v49, v228, v224, s85
    v_perm_b32 v50, v229, v225, s84
    v_perm_b32 v51, v229, v225, s85
    v_perm_b32 v52, v230, v226, s84
    v_perm_b32 v53, v230, v226, s85
    v_perm_b32 v54, v231, v227, s84
    v_perm_b32 v55, v231, v227, s85
    v_dot2_f32_bf16 v32, v48, v20, v32
    v_dot2_f32_bf16 v33, v49, v20, v33
    v_dot2_f32_bf16 v34, v50, v20, v34
    v_dot2_f32_bf16 v35, v51, v20, v35
    v_dot2_f32_bf16 v36, v52, v20, v36
    v_dot2_f32_bf16 v37, v53, v20, v37
    v_dot2_f32_bf16 v38, v54, v20, v38
    v_dot2_f32_bf16 v39, v55, v20, v39
    s_waitcnt vmcnt(6)
    v_dot2_f32_bf16 v40, v48, v28, v40
    v_dot2_f32_bf16 v41, v49, v28, v41
    v_dot2_f32_bf16 v42, v50, v28, v42
    v_dot2_f32_bf16 v43, v51, v28, v43
    v_dot2_f32_bf16 v44, v52, v28, v44
    v_dot2_f32_bf16 v45, v53, v28, v45
    v_dot2_f32_bf16 v46, v54, v28, v46
    v_dot2_f32_bf16 v47, v55, v28, v47
    v_perm_b32 v48, v236, v232, s84
    v_perm_b32 v49, v236, v232, s85
    v_perm_b32 v50, v237, v233, s84
    v_perm_b32 v51, v237, v233, s85
    v_perm_b32 v52, v238, v234, s84
    v_perm_b32 v53, v238, v234, s85
    v_perm_b32 v54, v239, v235, s84
    v_perm_b32 v55, v239, v235, s85
    v_dot2_f32_bf16 v32, v48, v21, v32
    v_dot2_f32_bf16 v33, v49, v21, v33
    v_dot2_f32_bf16 v34, v50, v21, v34
    v_dot2_f32_bf16 v35, v51, v21, v35
    v_dot2_f32_bf16 v36, v52, v21, v36
    v_dot2_f32_bf16 v37, v53, v21, v37
    v_dot2_f32_bf16 v38, v54, v21, v38
    v_dot2_f32_bf16 v39, v55, v21, v39
    v_dot2_f32_bf16 v40, v48, v29, v40
    v_dot2_f32_bf16 v41, v49, v29, v41
    v_dot2_f32_bf16 v42, v50, v29, v42
    v_dot2_f32_bf16 v43, v51, v29, v43
    v_dot2_f32_bf16 v44, v52, v29, v44
    v_dot2_f32_bf16 v45, v53, v29, v45
    v_dot2_f32_bf16 v46, v54, v29, v46
    v_dot2_f32_bf16 v47, v55, v29, v47
    v_perm_b32 v48, v244, v240, s84
    v_perm_b32 v49, v244, v240, s85
    v_perm_b32 v50, v245, v241, s84
    v_perm_b32 v51, v245, v241, s85
    v_perm_b32 v52, v246, v242, s84
    v_perm_b32 v53, v246, v242, s85
    v_perm_b32 v54, v247, v243, s84
    v_perm_b32 v55, v247, v243, s85
    v_dot2_f32_bf16 v32, v48, v22, v32
    v_dot2_f32_bf16 v33, v49, v22, v33
    v_dot2_f32_bf16 v34, v50, v22, v34
    v_dot2_f32_bf16 v35, v51, v22, v35
    v_dot2_f32_bf16 v36, v52, v22, v36
    v_dot2_f32_bf16 v37, v53, v22, v37
    v_dot2_f32_bf16 v38, v54, v22, v38
    v_dot2_f32_bf16 v39, v55, v22, v39
    v_dot2_f32_bf16 v40, v48, v30, v40
    v_dot2_f32_bf16 v41, v49, v30, v41
    v_dot2_f32_bf16 v42, v50, v30, v42
    v_dot2_f32_bf16 v43, v51, v30, v43
    v_dot2_f32_bf16 v44, v52, v30, v44
    v_dot2_f32_bf16 v45, v53, v30, v45
    v_dot2_f32_bf16 v46, v54, v30, v46
    v_dot2_f32_bf16 v47, v55, v30, v47
    v_permlane32_swap_b32 v32, v40
    v_permlane32_swap_b32 v33, v41
    v_permlane32_swap_b32 v34, v42
    v_permlane32_swap_b32 v35, v43
    v_permlane32_swap_b32 v36, v44
    v_permlane32_swap_b32 v37, v45
    v_permlane32_swap_b32 v38, v46
    v_permlane32_swap_b32 v39, v47
    v_pk_add_f32 v[32:33], v[32:33], v[40:41]
    v_pk_add_f32 v[36:37], v[36:37], v[44:45]
    v_pk_add_f32 v[34:35], v[34:35], v[42:43]
    v_pk_add_f32 v[38:39], v[38:39], v[46:47]
    v_permlane16_swap_b32 v32, v36
    v_permlane16_swap_b32 v33, v37
    v_permlane16_swap_b32 v34, v38
    v_permlane16_swap_b32 v35, v39
    v_pk_add_f32 v[32:33], v[32:33], v[36:37]
    v_pk_add_f32 v[34:35], v[34:35], v[38:39]
    s_nop 0
    v_add_f32_dpp v32, v32, v32 row_ror:8 row_mask:0xf bank_mask:0xf
    v_add_f32_dpp v33, v33, v33 row_ror:8 row_mask:0xf bank_mask:0xf
    v_add_f32_dpp v34, v34, v34 row_ror:8 row_mask:0xf bank_mask:0xf
    v_add_f32_dpp v35, v35, v35 row_ror:8 row_mask:0xf bank_mask:0xf
    s_mov_b32 exec_lo, 0x00ff00ff
    s_mov_b32 exec_hi, 0x00ff00ff
    global_store_dwordx4 v2, v[32:35], s[42:43] sc1
    s_mov_b64 exec, -1
    s_waitcnt vmcnt(2)
    buffer_load_dwordx4 v[88:91], v1, s[44:47], s86 offen offset:2048 nt
    s_waitcnt vmcnt(2)
    buffer_load_dwordx4 v[92:95], v1, s[44:47], s86 offen offset:3072 nt
    s_waitcnt vmcnt(2)
    buffer_load_dwordx4 v[96:99], v1, s[44:47], s87 offen offset:0 nt
    s_waitcnt vmcnt(2)
    buffer_load_dwordx4 v[100:103], v1, s[44:47], s87 offen offset:1024 nt
    s_waitcnt vmcnt(2)
    buffer_load_dwordx4 v[104:107], v1, s[44:47], s87 offen offset:2048 nt
    v_mov_b32 v14, 1
    s_mov_b64 exec, 1
    global_atomic_add v9, v14, s[40:41]
    s_mov_b64 exec, -1
    s_setprio 0
    s_waitcnt vmcnt(2)
    buffer_load_dwordx4 v[108:111], v1, s[44:47], s87 offen offset:3072 nt
    s_waitcnt vmcnt(2)
    buffer_load_dwordx4 v[112:115], v1, s[44:47], s88 offen offset:0 nt
    s_waitcnt vmcnt(2)
    buffer_load_dwordx4 v[116:119], v1, s[44:47], s88 offen offset:1024 nt
    s_waitcnt vmcnt(2)
    buffer_load_dwordx4 v[120:123], v1, s[44:47], s88 offen offset:2048 nt
    s_waitcnt vmcnt(2)
    buffer_load_dwordx4 v[124:127], v1, s[44:47], s88 offen offset:3072 nt
    s_waitcnt vmcnt(2)
    buffer_load_dwordx4 v[128:131], v1, s[44:47], s89 offen offset:0 nt
    s_waitcnt vmcnt(2)
    buffer_load_dwordx4 v[132:135], v1, s[44:47], s89 offen offset:1024 nt
    s_waitcnt vmcnt(2)
    buffer_load_dwordx4 v[136:139], v1, s[44:47], s89 offen offset:2048 nt
    s_waitcnt vmcnt(2)
    buffer_load_dwordx4 v[140:143], v1, s[44:47], s89 offen offset:3072 nt
    s_waitcnt vmcnt(2)
    buffer_load_dwordx4 v[144:147], v1, s[44:47], s90 offen offset:0 nt
    s_waitcnt vmcnt(2)
    buffer_load_dwordx4 v[148:151], v1, s[44:47], s90 offen offset:1024 nt
    s_waitcnt vmcnt(2)
    buffer_load_dwordx4 v[152:155], v1, s[44:47], s90 offen offset:2048 nt
    s_waitcnt vmcnt(2)
    buffer_load_dwordx4 v[156:159], v1, s[44:47], s90 offen offset:3072 nt
    s_waitcnt vmcnt(2)
    buffer_load_dwordx4 v[160:163], v1, s[44:47], s91 offen offset:0 nt
    s_waitcnt vmcnt(2)
    buffer_load_dwordx4 v[164:167], v1, s[44:47], s91 offen offset:1024 nt
    s_waitcnt vmcnt(2)
    buffer_load_dwordx4 v[168:171], v1, s[44:47], s91 offen offset:2048 nt
    s_waitcnt vmcnt(2)
    buffer_load_dwordx4 v[172:175], v1, s[44:47], s91 offen offset:3072 nt
    s_waitcnt vmcnt(2)
    buffer_load_dwordx4 v[176:179], v1, s[44:47], s92 offen offset:0 nt
    s_waitcnt vmcnt(2)
    buffer_load_dwordx4 v[180:183], v1, s[44:47], s92 offen offset:1024 nt
    s_waitcnt vmcnt(2)
    buffer_load_dwordx4 v[184:187], v1, s[44:47], s92 offen offset:2048 nt
    s_waitcnt vmcnt(2)
    buffer_load_dwordx4 v[188:191], v1, s[44:47], s92 offen offset:3072 nt
    s_waitcnt vmcnt(2)
    buffer_load_dwordx4 v[192:195], v1, s[48:51], 0 offen offset:0 nt
    s_waitcnt vmcnt(2)
    buffer_load_dwordx4 v[196:199], v1, s[48:51], 0 offen offset:1024 nt
    s_waitcnt vmcnt(2)
    buffer_load_dwordx4 v[200:203], v1, s[48:51], 0 offen offset:2048 nt
    s_waitcnt vmcnt(2)
    buffer_load_dwordx4 v[204:207], v1, s[48:51], 0 offen offset:3072 nt
    s_branch L_B1
L_QWAVE:
    s_setprio 3
    s_lshl_b32 s9, s5, 3
    s_add_u32 s9, s9, s6
    s_lshr_b32 s11, s9, 2
    s_and_b32 s10, s9, 3
    v_lshrrev_b32 v13, 3, v0
    v_and_b32 v14, 7, v0
    s_mul_i32 s95, s11, 917504
    s_lshl_b32 s93, s4, 9
    s_add_u32 s95, s95, s93
    s_lshl_b32 s93, s10, 7
    s_add_u32 s95, s95, s93
    v_mul_u32_u24 v11, 114688, v13
    v_lshl_add_u32 v11, v14, 4, v11
    v_mul_u32_u24 v15, 28, v13
    s_mul_i32 s94, s11, 224
    s_waitcnt lgkmcnt(0)
    s_add_u32 s52, s22, s95
    s_addc_u32 s53, s23, 0
    s_mov_b32 s54, 909440
    s_mov_b32 s55, 0x00020000
    buffer_load_dwordx4 v[192:195], v11, s[52:55], 0 offen nt
    s_mov_b32 s93, 8192
    buffer_load_dwordx4 v[196:199], v11, s[52:55], s93 offen nt
    s_mov_b32 s93, 16384
    buffer_load_dwordx4 v[200:203], v11, s[52:55], s93 offen nt
    s_mov_b32 s93, 24576
    buffer_load_dwordx4 v[204:207], v11, s[52:55], s93 offen nt
    s_mov_b32 s93, 32768
    buffer_load_dwordx4 v[208:211], v11, s[52:55], s93 offen nt
    s_mov_b32 s93, 40960
    buffer_load_dwordx4 v[212:215], v11, s[52:55], s93 offen nt
    s_mov_b32 s93, 49152
    buffer_load_dwordx4 v[216:219], v11, s[52:55], s93 offen nt
    s_mov_b32 s93, 57344
    buffer_load_dwordx4 v[220:223], v11, s[52:55], s93 offen nt
    s_mov_b32 s93, 65536
    buffer_load_dwordx4 v[224:227], v11, s[52:55], s93 offen nt
    s_mov_b32 s93, 73728
    buffer_load_dwordx4 v[228:231], v11, s[52:55], s93 offen nt
    s_mov_b32 s93, 81920
    buffer_load_dwordx4 v[232:235], v11, s[52:55], s93 offen nt
    s_mov_b32 s93, 90112
    buffer_load_dwordx4 v[236:239], v11, s[52:55], s93 offen nt
    s_mov_b32 s93, 98304
    buffer_load_dwordx4 v[240:243], v11, s[52:55], s93 offen nt
    s_mov_b32 s93, 106496
    buffer_load_dwordx4 v[244:247], v11, s[52:55], s93 offen nt
    s_mov_b32 s56, s16
    s_mov_b32 s57, s17
    s_mov_b32 s58, 1792
    s_mov_b32 s59, 0x00020000
    buffer_load_dwordx4 v[16:19], v15, s[56:59], s94 offen nt
    buffer_load_dwordx3 v[20:22], v15, s[56:59], s94 offen offset:16 nt
    buffer_load_dwordx4 v[24:27], v15, s[56:59], s94 offen offset:896 nt
    buffer_load_dwordx3 v[28:30], v15, s[56:59], s94 offen offset:912 nt
    v_mov_b32 v44, -1
    v_mov_b32 v45, -1
    v_mov_b32 v46, -1
    v_mov_b32 v47, -1
    s_lshl_b32 s95, s4, 3
    s_add_u32 s95, s95, s11
    s_lshl_b32 s95, s95, 10
    s_lshl_b32 s93, s10, 8
    s_add_u32 s95, s95, s93
    s_add_u32 s95, s95, 1572864
    v_lshlrev_b32 v2, 5, v14
    v_bfe_u32 v15, v0, 4, 1
    v_lshl_add_u32 v2, v15, 4, v2
    v_lshrrev_b32 v15, 5, v0
    v_lshl_add_u32 v2, v15, 12, v2
    v_add_u32 v2, s95, v2
    s_mov_b32 exec_lo, 0x00ff00ff
    s_mov_b32 exec_hi, 0x00ff00ff
    global_store_dwordx4 v2, v[44:47], s[42:43] sc1
    s_mov_b64 exec, -1
    s_lshl_b32 s93, s4, 15
    s_lshl_b32 s95, s9, 7
    s_add_u32 s95, s95, s93
    v_lshlrev_b32 v48, 12, v13
    v_lshl_add_u32 v48, v14, 4, v48
    v_add_u32 v48, s95, v48
    global_store_dwordx4 v48, v[44:47], s[42:43] sc1
    s_lshl_b32 s95, s9, 3
    s_add_u32 s95, s95, s93
    s_add_u32 s95, s95, 2048
    v_lshl_add_u32 v50, v0, 12, s95
    s_mov_b64 exec, 0xff
    global_store_dwordx2 v50, v[44:45], s[42:43] sc1
    s_mov_b64 exec, -1
    s_mul_i32 s93, s60, 524288
    s_lshl_b32 s95, s8, 6
    s_add_u32 s93, s93, s95
    s_add_u32 s93, s93, 524288
    v_lshrrev_b32 v51, 2, v0
    v_and_b32 v52, 3, v0
    v_lshlrev_b32 v51, 13, v51
    v_lshl_add_u32 v51, v52, 4, v51
    v_add_u32 v51, s93, v51
    v_add_u32 v52, 0x20000, v51
    v_add_u32 v53, 262144, v51
    v_add_u32 v54, 262144, v52
    global_store_dwordx4 v51, v[44:47], s[42:43] sc1
    global_store_dwordx4 v53, v[44:47], s[42:43] sc1
    s_mov_b32 exec_hi, 0xffff
    global_store_dwordx4 v52, v[44:47], s[42:43] sc1
    global_store_dwordx4 v54, v[44:47], s[42:43] sc1
    s_mov_b64 exec, -1
    s_lshl_b32 s94, s14, 21
    s_lshl_b32 s95, s6, 18
    s_add_u32 s94, s94, s95
    s_mul_i32 s95, s7, 4096
    s_add_u32 s94, s94, s95
    s_mov_b32 s86, 32768
    s_mov_b32 s87, 65536
    s_mov_b32 s88, 98304
    s_mov_b32 s89, 131072
    s_mov_b32 s90, 163840
    s_mov_b32 s91, 196608
    s_mov_b32 s92, 229376
    s_add_u32 s44, s18, s94
    s_addc_u32 s45, s19, 0
    s_mov_b32 s46, 233472
    s_mov_b32 s47, 0x00020000
    s_add_u32 s48, s20, s94
    s_addc_u32 s49, s21, 0
    s_mov_b32 s50, 233472
    s_mov_b32 s51, 0x00020000
    buffer_load_dwordx4 v[64:67], v1, s[44:47], 0 offen offset:0 nt
    buffer_load_dwordx4 v[68:71], v1, s[44:47], 0 offen offset:1024 nt
    buffer_load_dwordx4 v[72:75], v1, s[44:47], 0 offen offset:2048 nt
    buffer_load_dwordx4 v[76:79], v1, s[44:47], 0 offen offset:3072 nt
    buffer_load_dwordx4 v[80:83], v1, s[44:47], s86 offen offset:0 nt
    buffer_load_dwordx4 v[84:87], v1, s[44:47], s86 offen offset:1024 nt
    s_lshl_b32 s95, s4, 1
    s_add_u32 s95, s95, s5
    s_lshl_b32 s95, s95, 12
    s_add_u32 s95, s95, 1572864
    v_add_u32 v9, s95, v1
    s_lshl_b32 s94, s4, 3
    s_add_u32 s95, s94, s7
    s_lshl_b32 s95, s95, 12
    s_lshl_b32 s9, s5, 3
    s_add_u32 s9, s9, s6
    s_lshl_b32 s93, s9, 7
    s_add_u32 s93, s93, s95
    v_lshrrev_b32 v13, 3, v0
    v_and_b32 v14, 7, v0
    v_lshl_add_u32 v3, v13, 4, s93
    s_lshl_b32 s93, s9, 3
    s_add_u32 s93, s93, s95
    s_add_u32 s93, s93, 2048
    v_mov_b32 v4, s93
    s_lshl_b32 s95, s61, 3
    s_add_u32 s95, s95, s6
    s_lshl_b32 s95, s95, 12
    v_lshlrev_b32 v6, 7, v14
    v_lshl_add_u32 v6, v13, 4, v6
    v_add_u32 v6, s95, v6
    s_add_u32 s95, s95, 2048
    v_lshl_add_u32 v7, v14, 3, s95
    v_mul_u32_u24 v12, 1040, v14
    v_lshl_add_u32 v12, v13, 4, v12
    s_lshl_b32 s94, s7, 7
    s_add_u32 s94, s94, 0
    v_add_u32 v12, s94, v12
    v_lshrrev_b32 v13, 5, v0
    v_and_b32 v15, 31, v0
    v_lshlrev_b32 v13, 4, v13
    v_lshl_add_u32 v13, v15, 5, v13
    s_mul_i32 s94, s7, 1040
    s_add_u32 s94, s94, 0
    v_add_u32 v10, s94, v13
    s_mul_i32 s94, s60, 524288
    s_add_u32 s94, s94, 524288
    s_lshl_b32 s95, s7, 15
    s_add_u32 s95, s95, s94
    s_lshl_b32 s93, s8, 6
    s_add_u32 s95, s95, s93
    v_lshrrev_b32 v15, 1, v14
    v_lshlrev_b32 v5, 13, v15
    v_and_b32 v15, 1, v0
    v_lshl_add_u32 v5, v15, 5, v5
    v_lshrrev_b32 v15, 5, v0
    v_lshl_add_u32 v5, v15, 18, v5
    v_bfe_u32 v15, v0, 4, 1
    v_lshl_add_u32 v5, v15, 4, v5
    v_add_u32 v5, s95, v5
    s_cmp_ge_u32 s8, 28
    s_cselect_b32 s13, 1, 0
    s_mul_i32 s94, s13, 28
    s_sub_u32 s12, s8, s94
    s_min_u32 s12, s12, 27
    s_lshl_b32 s94, s13, 18
    s_add_u32 s94, s94, 524288
    s_lshl_b32 s95, s12, 13
    s_add_u32 s95, s95, s94
    v_and_b32 v15, 15, v0
    v_lshlrev_b32 v8, 6, v15
    v_lshrrev_b32 v15, 4, v0
    v_lshl_add_u32 v8, v15, 4, v8
    v_add_u32 v8, s95, v8
    s_mov_b32 s96, 0xcccccccc
    s_mov_b32 s97, 0xcccccccc
    s_mov_b32 s98, 0xaaaaaaaa
    s_mov_b32 s99, 0xaaaaaaaa
    s_waitcnt vmcnt(29)
    v_perm_b32 v48, v196, v192, s84
    v_perm_b32 v49, v196, v192, s85
    v_perm_b32 v50, v197, v193, s84
    v_perm_b32 v51, v197, v193, s85
    v_perm_b32 v52, v198, v194, s84
    v_perm_b32 v53, v198, v194, s85
    v_perm_b32 v54, v199, v195, s84
    v_perm_b32 v55, v199, v195, s85
    s_waitcnt vmcnt(16)
    v_dot2_f32_bf16 v32, v48, v16, 0
    v_dot2_f32_bf16 v33, v49, v16, 0
    v_dot2_f32_bf16 v34, v50, v16, 0
    v_dot2_f32_bf16 v35, v51, v16, 0
    v_dot2_f32_bf16 v36, v52, v16, 0
    v_dot2_f32_bf16 v37, v53, v16, 0
    v_dot2_f32_bf16 v38, v54, v16, 0
    v_dot2_f32_bf16 v39, v55, v16, 0
    s_waitcnt vmcnt(14)
    v_dot2_f32_bf16 v40, v48, v24, 0
    v_dot2_f32_bf16 v41, v49, v24, 0
    v_dot2_f32_bf16 v42, v50, v24, 0
    v_dot2_f32_bf16 v43, v51, v24, 0
    v_dot2_f32_bf16 v44, v52, v24, 0
    v_dot2_f32_bf16 v45, v53, v24, 0
    v_dot2_f32_bf16 v46, v54, v24, 0
    v_dot2_f32_bf16 v47, v55, v24, 0
    v_perm_b32 v48, v204, v200, s84
    v_perm_b32 v49, v204, v200, s85
    v_perm_b32 v50, v205, v201, s84
    v_perm_b32 v51, v205, v201, s85
    v_perm_b32 v52, v206, v202, s84
    v_perm_b32 v53, v206, v202, s85
    v_perm_b32 v54, v207, v203, s84
    v_perm_b32 v55, v207, v203, s85
    v_dot2_f32_bf16 v32, v48, v17, v32
    v_dot2_f32_bf16 v33, v49, v17, v33
    v_dot2_f32_bf16 v34, v50, v17, v34
    v_dot2_f32_bf16 v35, v51, v17, v35
    v_dot2_f32_bf16 v36, v52, v17, v36
    v_dot2_f32_bf16 v37, v53, v17, v37
    v_dot2_f32_bf16 v38, v54, v17, v38
    v_dot2_f32_bf16 v39, v55, v17, v39
    v_dot2_f32_bf16 v40, v48, v25, v40
    v_dot2_f32_bf16 v41, v49, v25, v41
    v_dot2_f32_bf16 v42, v50, v25, v42
    v_dot2_f32_bf16 v43, v51, v25, v43
    v_dot2_f32_bf16 v44, v52, v25, v44
    v_dot2_f32_bf16 v45, v53, v25, v45
    v_dot2_f32_bf16 v46, v54, v25, v46
    v_dot2_f32_bf16 v47, v55, v25, v47
    v_perm_b32 v48, v212, v208, s84
    v_perm_b32 v49, v212, v208, s85
    v_perm_b32 v50, v213, v209, s84
    v_perm_b32 v51, v213, v209, s85
    v_perm_b32 v52, v214, v210, s84
    v_perm_b32 v53, v214, v210, s85
    v_perm_b32 v54, v215, v211, s84
    v_perm_b32 v55, v215, v211, s85
    v_dot2_f32_bf16 v32, v48, v18, v32
    v_dot2_f32_bf16 v33, v49, v18, v33
    v_dot2_f32_bf16 v34, v50, v18, v34
    v_dot2_f32_bf16 v35, v51, v18, v35
    v_dot2_f32_bf16 v36, v52, v18, v36
    v_dot2_f32_bf16 v37, v53, v18, v37
    v_dot2_f32_bf16 v38, v54, v18, v38
    v_dot2_f32_bf16 v39, v55, v18, v39
    v_dot2_f32_bf16 v40, v48, v26, v40
    v_dot2_f32_bf16 v41, v49, v26, v41
    v_dot2_f32_bf16 v42, v50, v26, v42
    v_dot2_f32_bf16 v43, v51, v26, v43
    v_dot2_f32_bf16 v44, v52, v26, v44
    v_dot2_f32_bf16 v45, v53, v26, v45
    v_dot2_f32_bf16 v46, v54, v26, v46
    v_dot2_f32_bf16 v47, v55, v26, v47
    v_perm_b32 v48, v220, v216, s84
    v_perm_b32 v49, v220, v216, s85
    v_perm_b32 v50, v221, v217, s84
    v_perm_b32 v51, v221, v217, s85
    v_perm_b32 v52, v222, v218, s84
    v_perm_b32 v53, v222, v218, s85
    v_perm_b32 v54, v223, v219, s84
    v_perm_b32 v55, v223, v219, s85
    v_dot2_f32_bf16 v32, v48, v19, v32
    v_dot2_f32_bf16 v33, v49, v19, v33
    v_dot2_f32_bf16 v34, v50, v19, v34
    v_dot2_f32_bf16 v35, v51, v19, v35
    v_dot2_f32_bf16 v36, v52, v19, v36
    v_dot2_f32_bf16 v37, v53, v19, v37
    v_dot2_f32_bf16 v38, v54, v19, v38
    v_dot2_f32_bf16 v39, v55, v19, v39
    v_dot2_f32_bf16 v40, v48, v27, v40
    v_dot2_f32_bf16 v41, v49, v27, v41
    v_dot2_f32_bf16 v42, v50, v27, v42
    v_dot2_f32_bf16 v43, v51, v27, v43
    v_dot2_f32_bf16 v44, v52, v27, v44
    v_dot2_f32_bf16 v45, v53, v27, v45
    v_dot2_f32_bf16 v46, v54, v27, v46
    v_dot2_f32_bf16 v47, v55, v27, v47
    v_perm_b32 v48, v228, v224, s84
    v_perm_b32 v49, v228, v224, s85
    v_perm_b32 v50, v229, v225, s84
    v_perm_b32 v51, v229, v225, s85
    v_perm_b32 v52, v230, v226, s84
    v_perm_b32 v53, v230, v226, s85
    v_perm_b32 v54, v231, v227, s84
    v_perm_b32 v55, v231, v227, s85
    v_dot2_f32_bf16 v32, v48, v20, v32
    v_dot2_f32_bf16 v33, v49, v20, v33
    v_dot2_f32_bf16 v34, v50, v20, v34
    v_dot2_f32_bf16 v35, v51, v20, v35
    v_dot2_f32_bf16 v36, v52, v20, v36
    v_dot2_f32_bf16 v37, v53, v20, v37
    v_dot2_f32_bf16 v38, v54, v20, v38
    v_dot2_f32_bf16 v39, v55, v20, v39
    s_waitcnt vmcnt(13)
    v_dot2_f32_bf16 v40, v48, v28, v40
    v_dot2_f32_bf16 v41, v49, v28, v41
    v_dot2_f32_bf16 v42, v50, v28, v42
    v_dot2_f32_bf16 v43, v51, v28, v43
    v_dot2_f32_bf16 v44, v52, v28, v44
    v_dot2_f32_bf16 v45, v53, v28, v45
    v_dot2_f32_bf16 v46, v54, v28, v46
    v_dot2_f32_bf16 v47, v55, v28, v47
    v_perm_b32 v48, v236, v232, s84
    v_perm_b32 v49, v236, v232, s85
    v_perm_b32 v50, v237, v233, s84
    v_perm_b32 v51, v237, v233, s85
    v_perm_b32 v52, v238, v234, s84
    v_perm_b32 v53, v238, v234, s85
    v_perm_b32 v54, v239, v235, s84
    v_perm_b32 v55, v239, v235, s85
    v_dot2_f32_bf16 v32, v48, v21, v32
    v_dot2_f32_bf16 v33, v49, v21, v33
    v_dot2_f32_bf16 v34, v50, v21, v34
    v_dot2_f32_bf16 v35, v51, v21, v35
    v_dot2_f32_bf16 v36, v52, v21, v36
    v_dot2_f32_bf16 v37, v53, v21, v37
    v_dot2_f32_bf16 v38, v54, v21, v38
    v_dot2_f32_bf16 v39, v55, v21, v39
    v_dot2_f32_bf16 v40, v48, v29, v40
    v_dot2_f32_bf16 v41, v49, v29, v41
    v_dot2_f32_bf16 v42, v50, v29, v42
    v_dot2_f32_bf16 v43, v51, v29, v43
    v_dot2_f32_bf16 v44, v52, v29, v44
    v_dot2_f32_bf16 v45, v53, v29, v45
    v_dot2_f32_bf16 v46, v54, v29, v46
    v_dot2_f32_bf16 v47, v55, v29, v47
    v_perm_b32 v48, v244, v240, s84
    v_perm_b32 v49, v244, v240, s85
    v_perm_b32 v50, v245, v241, s84
    v_perm_b32 v51, v245, v241, s85
    v_perm_b32 v52, v246, v242, s84
    v_perm_b32 v53, v246, v242, s85
    v_perm_b32 v54, v247, v243, s84
    v_perm_b32 v55, v247, v243, s85
    v_dot2_f32_bf16 v32, v48, v22, v32
    v_dot2_f32_bf16 v33, v49, v22, v33
    v_dot2_f32_bf16 v34, v50, v22, v34
    v_dot2_f32_bf16 v35, v51, v22, v35
    v_dot2_f32_bf16 v36, v52, v22, v36
    v_dot2_f32_bf16 v37, v53, v22, v37
    v_dot2_f32_bf16 v38, v54, v22, v38
    v_dot2_f32_bf16 v39, v55, v22, v39
    v_dot2_f32_bf16 v40, v48, v30, v40
    v_dot2_f32_bf16 v41, v49, v30, v41
    v_dot2_f32_bf16 v42, v50, v30, v42
    v_dot2_f32_bf16 v43, v51, v30, v43
    v_dot2_f32_bf16 v44, v52, v30, v44
    v_dot2_f32_bf16 v45, v53, v30, v45
    v_dot2_f32_bf16 v46, v54, v30, v46
    v_dot2_f32_bf16 v47, v55, v30, v47
    v_permlane32_swap_b32 v32, v40
    v_permlane32_swap_b32 v33, v41
    v_permlane32_swap_b32 v34, v42
    v_permlane32_swap_b32 v35, v43
    v_permlane32_swap_b32 v36, v44
    v_permlane32_swap_b32 v37, v45
    v_permlane32_swap_b32 v38, v46
    v_permlane32_swap_b32 v39, v47
    v_pk_add_f32 v[32:33], v[32:33], v[40:41]
    v_pk_add_f32 v[36:37], v[36:37], v[44:45]
    v_pk_add_f32 v[34:35], v[34:35], v[42:43]
    v_pk_add_f32 v[38:39], v[38:39], v[46:47]
    v_permlane16_swap_b32 v32, v36
    v_permlane16_swap_b32 v33, v37
    v_permlane16_swap_b32 v34, v38
    v_permlane16_swap_b32 v35, v39
    v_pk_add_f32 v[32:33], v[32:33], v[36:37]
    v_pk_add_f32 v[34:35], v[34:35], v[38:39]
    s_nop 0
    v_add_f32_dpp v32, v32, v32 row_ror:8 row_mask:0xf bank_mask:0xf
    v_add_f32_dpp v33, v33, v33 row_ror:8 row_mask:0xf bank_mask:0xf
    v_add_f32_dpp v34, v34, v34 row_ror:8 row_mask:0xf bank_mask:0xf
    v_add_f32_dpp v35, v35, v35 row_ror:8 row_mask:0xf bank_mask:0xf
    s_lshl_b32 s94, s14, 2
    s_add_u32 s94, s94, 128
    v_mov_b32 v13, s94
    v_mov_b32 v14, 1
    s_waitcnt vmcnt(6)
    s_mov_b32 exec_lo, 0x00ff00ff
    s_mov_b32 exec_hi, 0x00ff00ff
    global_store_dwordx4 v2, v[32:35], s[42:43] sc1
    s_mov_b64 exec, 1
    global_atomic_add v13, v14, s[40:41]
    s_mov_b64 exec, -1
    s_waitcnt vmcnt(2)
    buffer_load_dwordx4 v[88:91], v1, s[44:47], s86 offen offset:2048 nt
    s_waitcnt vmcnt(2)
    buffer_load_dwordx4 v[92:95], v1, s[44:47], s86 offen offset:3072 nt
    s_waitcnt vmcnt(2)
    buffer_load_dwordx4 v[96:99], v1, s[44:47], s87 offen offset:0 nt
    s_waitcnt vmcnt(2)
    buffer_load_dwordx4 v[100:103], v1, s[44:47], s87 offen offset:1024 nt
    s_waitcnt vmcnt(2)
    buffer_load_dwordx4 v[104:107], v1, s[44:47], s87 offen offset:2048 nt
    s_waitcnt vmcnt(2)
    buffer_load_dwordx4 v[108:111], v1, s[44:47], s87 offen offset:3072 nt
    s_waitcnt vmcnt(2)
    buffer_load_dwordx4 v[112:115], v1, s[44:47], s88 offen offset:0 nt
    s_waitcnt vmcnt(2)
    buffer_load_dwordx4 v[116:119], v1, s[44:47], s88 offen offset:1024 nt
    s_waitcnt vmcnt(2)
    buffer_load_dwordx4 v[120:123], v1, s[44:47], s88 offen offset:2048 nt
    s_waitcnt vmcnt(2)
    buffer_load_dwordx4 v[124:127], v1, s[44:47], s88 offen offset:3072 nt
    s_waitcnt vmcnt(2)
    buffer_load_dwordx4 v[128:131], v1, s[44:47], s89 offen offset:0 nt
    s_waitcnt vmcnt(2)
    buffer_load_dwordx4 v[132:135], v1, s[44:47], s89 offen offset:1024 nt
    s_waitcnt vmcnt(2)
    buffer_load_dwordx4 v[136:139], v1, s[44:47], s89 offen offset:2048 nt
    s_waitcnt vmcnt(2)
    buffer_load_dwordx4 v[140:143], v1, s[44:47], s89 offen offset:3072 nt
    v_and_b32 v13, 1, v0
    s_lshl_b32 s94, s4, 2
    s_add_u32 s94, s94, 128
    v_lshl_add_u32 v15, v13, 6, s94
    global_load_dword v14, v15, s[40:41] sc1
    s_waitcnt vmcnt(2)
    buffer_load_dwordx4 v[144:147], v1, s[44:47], s90 offen offset:0 nt
    s_waitcnt vmcnt(2)
    buffer_load_dwordx4 v[148:151], v1, s[44:47], s90 offen offset:1024 nt
    s_waitcnt vmcnt(2)
    buffer_load_dwordx4 v[152:155], v1, s[44:47], s90 offen offset:2048 nt
    s_waitcnt vmcnt(2)
    buffer_load_dwordx4 v[156:159], v1, s[44:47], s90 offen offset:3072 nt
    s_waitcnt vmcnt(2)
    buffer_load_dwordx4 v[160:163], v1, s[44:47], s91 offen offset:0 nt
    v_cmp_ne_u32 vcc, 8, v14
    s_cbranch_vccnz L_QCHK_SLOW
L_QCHK_OK:
    global_load_dwordx4 v[48:51], v9, s[42:43] offset:0 sc1
    global_load_dwordx4 v[52:55], v9, s[42:43] offset:1024 sc1
    global_load_dwordx4 v[56:59], v9, s[42:43] offset:2048 sc1
    global_load_dwordx4 v[60:63], v9, s[42:43] offset:3072 sc1
    s_waitcnt vmcnt(2)
    buffer_load_dwordx4 v[164:167], v1, s[44:47], s91 offen offset:1024 nt
    s_waitcnt vmcnt(2)
    buffer_load_dwordx4 v[168:171], v1, s[44:47], s91 offen offset:2048 nt
    s_waitcnt vmcnt(2)
    buffer_load_dwordx4 v[172:175], v1, s[44:47], s91 offen offset:3072 nt
    s_waitcnt vmcnt(2)
    buffer_load_dwordx4 v[176:179], v1, s[44:47], s92 offen offset:0 nt
    s_waitcnt vmcnt(2)
    buffer_load_dwordx4 v[180:183], v1, s[44:47], s92 offen offset:1024 nt
    v_max3_u32 v44, v48, v49, v50
    v_max3_u32 v45, v51, v52, v53
    v_max3_u32 v46, v54, v55, v56
    v_max3_u32 v47, v57, v58, v59
    v_max3_u32 v44, v44, v60, v61
    v_max3_u32 v45, v45, v62, v63
    v_max3_u32 v44, v44, v46, v47
    v_max_u32 v44, v44, v45
    v_cmp_eq_u32 vcc, -1, v44
    s_cbranch_vccnz L_QPOLL_SLOW
L_QPOLL_OK:
    v_add_f32 v48, v48, v52
    v_add_f32 v56, v56, v60
    v_add_f32 v49, v49, v53
    v_add_f32 v57, v57, v61
    v_add_f32 v50, v50, v54
    v_add_f32 v58, v58, v62
    v_add_f32 v51, v51, v55
    v_add_f32 v59, v59, v63
    v_add_f32 v48, v48, v56
    v_add_f32 v49, v49, v57
    v_add_f32 v50, v50, v58
    v_add_f32 v51, v51, v59
    v_cvt_pk_bf16_f32 v48, v48, v49
    v_cvt_pk_bf16_f32 v49, v50, v51
    v_lshlrev_b32 v13, 3, v0
    ds_write_b64 v13, v[48:49] offset:8512
    s_setprio 0
    s_waitcnt vmcnt(2)
    buffer_load_dwordx4 v[184:187], v1, s[44:47], s92 offen offset:2048 nt
    s_waitcnt vmcnt(2)
    buffer_load_dwordx4 v[188:191], v1, s[44:47], s92 offen offset:3072 nt
    s_waitcnt vmcnt(2)
    buffer_load_dwordx4 v[192:195], v1, s[48:51], 0 offen offset:0 nt
    s_waitcnt vmcnt(2)
    buffer_load_dwordx4 v[196:199], v1, s[48:51], 0 offen offset:1024 nt
    s_waitcnt vmcnt(2)
    buffer_load_dwordx4 v[200:203], v1, s[48:51], 0 offen offset:2048 nt
    s_waitcnt vmcnt(2)
    buffer_load_dwordx4 v[204:207], v1, s[48:51], 0 offen offset:3072 nt
    s_waitcnt lgkmcnt(0)
L_B1:
    s_barrier
    v_and_b32 v13, 31, v0
    v_lshlrev_b32 v13, 4, v13
    ds_read_b128 v[40:43], v13 offset:8512
    s_waitcnt lgkmcnt(0)
    v_dot2_f32_bf16 v24, v64, v40, 0
    v_dot2_f32_bf16 v25, v68, v40, 0
    v_dot2_f32_bf16 v24, v65, v41, v24
    v_dot2_f32_bf16 v25, v69, v41, v25
    v_dot2_f32_bf16 v24, v66, v42, v24
    v_dot2_f32_bf16 v25, v70, v42, v25
    v_dot2_f32_bf16 v24, v67, v43, v24
    v_dot2_f32_bf16 v25, v71, v43, v25
    s_waitcnt vmcnt(3)
    buffer_load_dwordx4 v[208:211], v1, s[48:51], s86 offen offset:0 nt
    s_nop 0
    v_permlane16_swap_b32 v24, v25
    v_add_f32 v24, v24, v25
    v_dot2_f32_bf16 v26, v72, v40, 0
    v_dot2_f32_bf16 v27, v76, v40, 0
    v_dot2_f32_bf16 v26, v73, v41, v26
    v_dot2_f32_bf16 v27, v77, v41, v27
    v_dot2_f32_bf16 v26, v74, v42, v26
    v_dot2_f32_bf16 v27, v78, v42, v27
    v_dot2_f32_bf16 v26, v75, v43, v26
    v_dot2_f32_bf16 v27, v79, v43, v27
    s_waitcnt vmcnt(3)
    buffer_load_dwordx4 v[212:215], v1, s[48:51], s86 offen offset:1024 nt
    s_nop 0
    v_permlane16_swap_b32 v26, v27
    v_add_f32 v26, v26, v27
    v_dot2_f32_bf16 v28, v80, v40, 0
    v_dot2_f32_bf16 v29, v84, v40, 0
    v_dot2_f32_bf16 v28, v81, v41, v28
    v_dot2_f32_bf16 v29, v85, v41, v29
    v_dot2_f32_bf16 v28, v82, v42, v28
    v_dot2_f32_bf16 v29, v86, v42, v29
    v_dot2_f32_bf16 v28, v83, v43, v28
    v_dot2_f32_bf16 v29, v87, v43, v29
    s_waitcnt vmcnt(3)
    buffer_load_dwordx4 v[216:219], v1, s[48:51], s86 offen offset:2048 nt
    v_add_f32_dpp v30, v24, v24 row_ror:8 row_mask:0xf bank_mask:0x3
    s_nop 1
    v_add_f32_dpp v30, v26, v26 row_ror:8 row_mask:0xf bank_mask:0xc
    v_permlane16_swap_b32 v28, v29
    v_add_f32 v28, v28, v29
    v_dot2_f32_bf16 v56, v88, v40, 0
    v_dot2_f32_bf16 v57, v92, v40, 0
    v_dot2_f32_bf16 v56, v89, v41, v56
    v_dot2_f32_bf16 v57, v93, v41, v57
    v_dot2_f32_bf16 v56, v90, v42, v56
    v_dot2_f32_bf16 v57, v94, v42, v57
    v_dot2_f32_bf16 v56, v91, v43, v56
    v_dot2_f32_bf16 v57, v95, v43, v57
    s_nop 2
    v_permlane16_swap_b32 v56, v57
    v_add_f32 v56, v56, v57
    v_dot2_f32_bf16 v58, v96, v40, 0
    v_dot2_f32_bf16 v59, v100, v40, 0
    v_dot2_f32_bf16 v58, v97, v41, v58
    v_dot2_f32_bf16 v59, v101, v41, v59
    v_dot2_f32_bf16 v58, v98, v42, v58
    v_dot2_f32_bf16 v59, v102, v42, v59
    v_dot2_f32_bf16 v58, v99, v43, v58
    v_dot2_f32_bf16 v59, v103, v43, v59
    s_waitcnt vmcnt(3)
    buffer_load_dwordx4 v[220:223], v1, s[48:51], s86 offen offset:3072 nt
    v_add_f32_dpp v60, v28, v28 row_ror:8 row_mask:0xf bank_mask:0x3
    s_nop 1
    v_add_f32_dpp v60, v56, v56 row_ror:8 row_mask:0xf bank_mask:0xc
    v_permlane16_swap_b32 v58, v59
    v_add_f32 v58, v58, v59
    v_dot2_f32_bf16 v61, v104, v40, 0
    v_dot2_f32_bf16 v62, v108, v40, 0
    v_dot2_f32_bf16 v61, v105, v41, v61
    v_dot2_f32_bf16 v62, v109, v41, v62
    v_dot2_f32_bf16 v61, v106, v42, v61
    v_dot2_f32_bf16 v62, v110, v42, v62
    v_dot2_f32_bf16 v61, v107, v43, v61
    v_dot2_f32_bf16 v62, v111, v43, v62
    s_waitcnt vmcnt(3)
    buffer_load_dwordx4 v[224:227], v1, s[48:51], s87 offen offset:0 nt
    v_add_f32_dpp v63, v30, v30 row_shl:4 row_mask:0xf bank_mask:0x5
    s_nop 1
    v_add_f32_dpp v63, v60, v60 row_shr:4 row_mask:0xf bank_mask:0xa
    v_permlane16_swap_b32 v61, v62
    v_add_f32 v61, v61, v62
    v_dot2_f32_bf16 v48, v112, v40, 0
    v_dot2_f32_bf16 v49, v116, v40, 0
    v_dot2_f32_bf16 v48, v113, v41, v48
    v_dot2_f32_bf16 v49, v117, v41, v49
    v_dot2_f32_bf16 v48, v114, v42, v48
    v_dot2_f32_bf16 v49, v118, v42, v49
    v_dot2_f32_bf16 v48, v115, v43, v48
    v_dot2_f32_bf16 v49, v119, v43, v49
    s_waitcnt vmcnt(3)
    buffer_load_dwordx4 v[228:231], v1, s[48:51], s87 offen offset:1024 nt
    v_add_f32_dpp v50, v58, v58 row_ror:8 row_mask:0xf bank_mask:0x3
    s_nop 1
    v_add_f32_dpp v50, v61, v61 row_ror:8 row_mask:0xf bank_mask:0xc
    v_permlane16_swap_b32 v48, v49
    v_add_f32 v48, v48, v49
    v_dot2_f32_bf16 v51, v120, v40, 0
    v_dot2_f32_bf16 v52, v124, v40, 0
    v_dot2_f32_bf16 v51, v121, v41, v51
    v_dot2_f32_bf16 v52, v125, v41, v52
    v_dot2_f32_bf16 v51, v122, v42, v51
    v_dot2_f32_bf16 v52, v126, v42, v52
    v_dot2_f32_bf16 v51, v123, v43, v51
    v_dot2_f32_bf16 v52, v127, v43, v52
    s_nop 2
    v_permlane16_swap_b32 v51, v52
    v_add_f32 v51, v51, v52
    v_dot2_f32_bf16 v53, v128, v40, 0
    v_dot2_f32_bf16 v54, v132, v40, 0
    v_dot2_f32_bf16 v53, v129, v41, v53
    v_dot2_f32_bf16 v54, v133, v41, v54
    v_dot2_f32_bf16 v53, v130, v42, v53
    v_dot2_f32_bf16 v54, v134, v42, v54
    v_dot2_f32_bf16 v53, v131, v43, v53
    v_dot2_f32_bf16 v54, v135, v43, v54
    s_waitcnt vmcnt(3)
    buffer_load_dwordx4 v[232:235], v1, s[48:51], s87 offen offset:2048 nt
    v_add_f32_dpp v55, v48, v48 row_ror:8 row_mask:0xf bank_mask:0x3
    s_nop 1
    v_add_f32_dpp v55, v51, v51 row_ror:8 row_mask:0xf bank_mask:0xc
    v_permlane16_swap_b32 v53, v54
    v_add_f32 v53, v53, v54
    v_dot2_f32_bf16 v31, v136, v40, 0
    v_dot2_f32_bf16 v25, v140, v40, 0
    v_dot2_f32_bf16 v31, v137, v41, v31
    v_dot2_f32_bf16 v25, v141, v41, v25
    v_dot2_f32_bf16 v31, v138, v42, v31
    v_dot2_f32_bf16 v25, v142, v42, v25
    v_dot2_f32_bf16 v31, v139, v43, v31
    v_dot2_f32_bf16 v25, v143, v43, v25
    s_waitcnt vmcnt(3)
    buffer_load_dwordx4 v[236:239], v1, s[48:51], s87 offen offset:3072 nt
    v_add_f32_dpp v27, v50, v50 row_shl:4 row_mask:0xf bank_mask:0x5
    s_nop 1
    v_add_f32_dpp v27, v55, v55 row_shr:4 row_mask:0xf bank_mask:0xa
    v_permlane16_swap_b32 v31, v25
    v_add_f32 v31, v31, v25
    v_dot2_f32_bf16 v24, v144, v40, 0
    v_dot2_f32_bf16 v26, v148, v40, 0
    v_dot2_f32_bf16 v24, v145, v41, v24
    v_dot2_f32_bf16 v26, v149, v41, v26
    v_dot2_f32_bf16 v24, v146, v42, v24
    v_dot2_f32_bf16 v26, v150, v42, v26
    v_dot2_f32_bf16 v24, v147, v43, v24
    v_dot2_f32_bf16 v26, v151, v43, v26
    s_waitcnt vmcnt(3)
    buffer_load_dwordx4 v[240:243], v1, s[48:51], s88 offen offset:0 nt
    v_add_f32_dpp v63, v63, v63 quad_perm:[2,3,0,1] row_mask:0xf bank_mask:0xf
    v_add_f32_dpp v27, v27, v27 quad_perm:[2,3,0,1] row_mask:0xf bank_mask:0xf
    v_cndmask_b32_e64 v63, v63, v27, s[96:97]
    v_add_f32_dpp v29, v53, v53 row_ror:8 row_mask:0xf bank_mask:0x3
    s_nop 1
    v_add_f32_dpp v29, v31, v31 row_ror:8 row_mask:0xf bank_mask:0xc
    v_permlane16_swap_b32 v24, v26
    v_add_f32 v24, v24, v26
    v_dot2_f32_bf16 v57, v152, v40, 0
    v_dot2_f32_bf16 v28, v156, v40, 0
    v_dot2_f32_bf16 v57, v153, v41, v57
    v_dot2_f32_bf16 v28, v157, v41, v28
    v_dot2_f32_bf16 v57, v154, v42, v57
    v_dot2_f32_bf16 v28, v158, v42, v28
    v_dot2_f32_bf16 v57, v155, v43, v57
    v_dot2_f32_bf16 v28, v159, v43, v28
    s_nop 2
    v_permlane16_swap_b32 v57, v28
    v_add_f32 v57, v57, v28
    v_dot2_f32_bf16 v56, v160, v40, 0
    v_dot2_f32_bf16 v59, v164, v40, 0
    v_dot2_f32_bf16 v56, v161, v41, v56
    v_dot2_f32_bf16 v59, v165, v41, v59
    v_dot2_f32_bf16 v56, v162, v42, v56
    v_dot2_f32_bf16 v59, v166, v42, v59
    v_dot2_f32_bf16 v56, v163, v43, v56
    v_dot2_f32_bf16 v59, v167, v43, v59
    s_waitcnt vmcnt(3)
    buffer_load_dwordx4 v[244:247], v1, s[48:51], s88 offen offset:1024 nt
    v_add_f32_dpp v30, v24, v24 row_ror:8 row_mask:0xf bank_mask:0x3
    s_nop 1
    v_add_f32_dpp v30, v57, v57 row_ror:8 row_mask:0xf bank_mask:0xc
    v_permlane16_swap_b32 v56, v59
    v_add_f32 v56, v56, v59
    v_dot2_f32_bf16 v60, v168, v40, 0
    v_dot2_f32_bf16 v62, v172, v40, 0
    v_dot2_f32_bf16 v60, v169, v41, v60
    v_dot2_f32_bf16 v62, v173, v41, v62
    v_dot2_f32_bf16 v60, v170, v42, v60
    v_dot2_f32_bf16 v62, v174, v42, v62
    v_dot2_f32_bf16 v60, v171, v43, v60
    v_dot2_f32_bf16 v62, v175, v43, v62
    s_waitcnt vmcnt(3)
    buffer_load_dwordx4 v[248:251], v1, s[48:51], s88 offen offset:2048 nt
    v_add_f32_dpp v58, v29, v29 row_shl:4 row_mask:0xf bank_mask:0x5
    s_nop 1
    v_add_f32_dpp v58, v30, v30 row_shr:4 row_mask:0xf bank_mask:0xa
    v_permlane16_swap_b32 v60, v62
    v_add_f32 v60, v60, v62
    v_dot2_f32_bf16 v61, v176, v40, 0
    v_dot2_f32_bf16 v49, v180, v40, 0
    v_dot2_f32_bf16 v61, v177, v41, v61
    v_dot2_f32_bf16 v49, v181, v41, v49
    v_dot2_f32_bf16 v61, v178, v42, v61
    v_dot2_f32_bf16 v49, v182, v42, v49
    v_dot2_f32_bf16 v61, v179, v43, v61
    v_dot2_f32_bf16 v49, v183, v43, v49
    s_waitcnt vmcnt(3)
    buffer_load_dwordx4 v[252:255], v1, s[48:51], s88 offen offset:3072 nt
    v_add_f32_dpp v52, v56, v56 row_ror:8 row_mask:0xf bank_mask:0x3
    s_nop 1
    v_add_f32_dpp v52, v60, v60 row_ror:8 row_mask:0xf bank_mask:0xc
    v_permlane16_swap_b32 v61, v49
    v_add_f32 v61, v61, v49
    v_dot2_f32_bf16 v48, v184, v40, 0
    v_dot2_f32_bf16 v51, v188, v40, 0
    v_dot2_f32_bf16 v48, v185, v41, v48
    v_dot2_f32_bf16 v51, v189, v41, v51
    v_dot2_f32_bf16 v48, v186, v42, v48
    v_dot2_f32_bf16 v51, v190, v42, v51
    v_dot2_f32_bf16 v48, v187, v43, v48
    v_dot2_f32_bf16 v51, v191, v43, v51
    s_nop 2
    v_permlane16_swap_b32 v48, v51
    v_add_f32 v48, v48, v51
    v_add_f32_dpp v54, v61, v61 row_ror:8 row_mask:0xf bank_mask:0x3
    s_nop 1
    v_add_f32_dpp v54, v48, v48 row_ror:8 row_mask:0xf bank_mask:0xc
    v_add_f32_dpp v50, v52, v52 row_shl:4 row_mask:0xf bank_mask:0x5
    s_nop 1
    v_add_f32_dpp v50, v54, v54 row_shr:4 row_mask:0xf bank_mask:0xa
    v_add_f32_dpp v58, v58, v58 quad_perm:[2,3,0,1] row_mask:0xf bank_mask:0xf
    s_nop 0
    v_add_f32_dpp v50, v50, v50 quad_perm:[2,3,0,1] row_mask:0xf bank_mask:0xf
    v_cndmask_b32_e64 v58, v58, v50, s[96:97]
    v_add_f32_dpp v63, v63, v63 quad_perm:[1,0,3,2] row_mask:0xf bank_mask:0xf
    s_nop 0
    v_add_f32_dpp v58, v58, v58 quad_perm:[1,0,3,2] row_mask:0xf bank_mask:0xf
    v_cndmask_b32_e64 v63, v63, v58, s[98:99]
    v_cvt_pk_bf16_f32 v30, v63, v63
    v_and_b32 v30, 0xffff0000, v30
    v_mov_b32 v54, v30
    s_nop 1
    v_max_f32_dpp v54, v54, v54 row_ror:8 row_mask:0xf bank_mask:0xf
    s_nop 1
    v_max_f32_dpp v54, v54, v54 row_ror:4 row_mask:0xf bank_mask:0xf
    s_nop 1
    v_max_f32_dpp v54, v54, v54 row_ror:2 row_mask:0xf bank_mask:0xf
    s_nop 1
    v_max_f32_dpp v54, v54, v54 row_ror:1 row_mask:0xf bank_mask:0xf
    v_mov_b32 v29, v54
    s_nop 1
    v_permlane16_swap_b32 v54, v29
    v_max_f32 v54, v54, v29
    v_mov_b32 v29, v54
    s_nop 1
    v_permlane32_swap_b32 v54, v29
    v_max_f32 v54, v54, v29
    s_lshl_b32 s94, s7, 2
    s_add_u32 s94, s94, 8320
    v_mov_b32 v13, s94
    v_sub_f32 v28, v30, v54
    v_mul_f32 v28, 0x3db8aa3b, v28
    v_exp_f32 v28, v28
    ds_write_b32 v13, v54
    v_mov_b32 v30, v28
    v_mov_b32 v29, v28
    s_nop 1
    v_permlane16_swap_b32 v30, v29
    v_cvt_pk_bf16_f32 v30, v30, v29
    ds_swizzle_b32 v176, v30 offset:0
    ds_swizzle_b32 v177, v30 offset:256
    ds_swizzle_b32 v178, v30 offset:128
    ds_swizzle_b32 v179, v30 offset:384
    ds_swizzle_b32 v180, v30 offset:64
    ds_swizzle_b32 v181, v30 offset:320
    ds_swizzle_b32 v182, v30 offset:192
    ds_swizzle_b32 v183, v30 offset:448
    ds_swizzle_b32 v184, v30 offset:32
    ds_swizzle_b32 v185, v30 offset:288
    ds_swizzle_b32 v186, v30 offset:160
    ds_swizzle_b32 v187, v30 offset:416
    ds_swizzle_b32 v188, v30 offset:96
    ds_swizzle_b32 v189, v30 offset:352
    s_waitcnt lgkmcnt(13)
    ds_swizzle_b32 v190, v30 offset:224
    ds_swizzle_b32 v191, v30 offset:480
    v_add_f32_dpp v28, v28, v28 row_ror:8 row_mask:0xf bank_mask:0xf
    s_nop 1
    v_add_f32_dpp v28, v28, v28 row_ror:4 row_mask:0xf bank_mask:0xf
    s_nop 1
    v_add_f32_dpp v28, v28, v28 row_ror:2 row_mask:0xf bank_mask:0xf
    s_nop 1
    v_add_f32_dpp v28, v28, v28 row_ror:1 row_mask:0xf bank_mask:0xf
    v_mov_b32 v29, v28
    s_nop 1
    v_permlane16_swap_b32 v28, v29
    v_add_f32 v28, v28, v29
    v_mov_b32 v29, v28
    s_nop 1
    v_permlane32_swap_b32 v28, v29
    v_add_f32 v28, v28, v29
    s_waitcnt lgkmcnt(13)
    ds_write_b32 v13, v28 offset:32
    s_cmp_eq_u32 s7, 7
    s_cbranch_scc1 L_PWAVE
    s_lshl_b32 s94, s61, 8
    s_lshl_b32 s93, s6, 5
    s_add_u32 s94, s94, s93
    s_min_u32 s95, s8, 111
    s_lshl_b32 s95, s95, 4
    s_cmp_lt_u32 s8, 112
    s_cselect_b32 s93, 13568, 0
    s_cmp_eq_u32 s60, 0
    s_cselect_b32 s94, s94, s95
    s_cselect_b32 s70, 27904, s93
    s_cselect_b32 s68, s24, s32
    s_cselect_b32 s69, s25, s33
    s_mul_i32 s94, s94, 896
    s_lshl_b32 s95, s7, 7
    s_add_u32 s94, s94, s95
    s_add_u32 s68, s68, s94
    s_addc_u32 s69, s69, 0
    s_mov_b32 s71, 0x00020000
    v_perm_b32 v56, v196, v192, s84
    v_perm_b32 v57, v196, v192, s85
    v_perm_b32 v58, v197, v193, s84
    v_perm_b32 v59, v197, v193, s85
    v_perm_b32 v60, v198, v194, s84
    v_perm_b32 v61, v198, v194, s85
    v_perm_b32 v62, v199, v195, s84
    v_perm_b32 v63, v199, v195, s85
    v_dot2_f32_bf16 v32, v56, v176, 0
    v_dot2_f32_bf16 v33, v57, v176, 0
    v_dot2_f32_bf16 v34, v58, v176, 0
    v_dot2_f32_bf16 v35, v59, v176, 0
    v_dot2_f32_bf16 v36, v60, v176, 0
    v_dot2_f32_bf16 v37, v61, v176, 0
    v_dot2_f32_bf16 v38, v62, v176, 0
    v_dot2_f32_bf16 v39, v63, v176, 0
    v_perm_b32 v56, v204, v200, s84
    v_perm_b32 v57, v204, v200, s85
    v_perm_b32 v58, v205, v201, s84
    v_perm_b32 v59, v205, v201, s85
    v_perm_b32 v60, v206, v202, s84
    v_perm_b32 v61, v206, v202, s85
    v_perm_b32 v62, v207, v203, s84
    v_perm_b32 v63, v207, v203, s85
    v_dot2_f32_bf16 v32, v56, v177, v32
    v_dot2_f32_bf16 v33, v57, v177, v33
    v_dot2_f32_bf16 v34, v58, v177, v34
    v_dot2_f32_bf16 v35, v59, v177, v35
    v_dot2_f32_bf16 v36, v60, v177, v36
    v_dot2_f32_bf16 v37, v61, v177, v37
    v_dot2_f32_bf16 v38, v62, v177, v38
    v_dot2_f32_bf16 v39, v63, v177, v39
    v_perm_b32 v56, v212, v208, s84
    v_perm_b32 v57, v212, v208, s85
    v_perm_b32 v58, v213, v209, s84
    v_perm_b32 v59, v213, v209, s85
    v_perm_b32 v60, v214, v210, s84
    v_perm_b32 v61, v214, v210, s85
    v_perm_b32 v62, v215, v211, s84
    v_perm_b32 v63, v215, v211, s85
    v_dot2_f32_bf16 v32, v56, v178, v32
    v_dot2_f32_bf16 v33, v57, v178, v33
    v_dot2_f32_bf16 v34, v58, v178, v34
    v_dot2_f32_bf16 v35, v59, v178, v35
    v_dot2_f32_bf16 v36, v60, v178, v36
    v_dot2_f32_bf16 v37, v61, v178, v37
    v_dot2_f32_bf16 v38, v62, v178, v38
    v_dot2_f32_bf16 v39, v63, v178, v39
    s_waitcnt vmcnt(4)
    buffer_load_dwordx4 v[64:67], v1, s[48:51], s89 offen offset:0 nt
    s_waitcnt vmcnt(4)
    buffer_load_dwordx4 v[68:71], v1, s[48:51], s89 offen offset:1024 nt
    v_perm_b32 v56, v220, v216, s84
    v_perm_b32 v57, v220, v216, s85
    v_perm_b32 v58, v221, v217, s84
    v_perm_b32 v59, v221, v217, s85
    v_perm_b32 v60, v222, v218, s84
    v_perm_b32 v61, v222, v218, s85
    v_perm_b32 v62, v223, v219, s84
    v_perm_b32 v63, v223, v219, s85
    s_waitcnt lgkmcnt(13)
    v_dot2_f32_bf16 v32, v56, v179, v32
    v_dot2_f32_bf16 v33, v57, v179, v33
    v_dot2_f32_bf16 v34, v58, v179, v34
    v_dot2_f32_bf16 v35, v59, v179, v35
    v_dot2_f32_bf16 v36, v60, v179, v36
    v_dot2_f32_bf16 v37, v61, v179, v37
    v_dot2_f32_bf16 v38, v62, v179, v38
    v_dot2_f32_bf16 v39, v63, v179, v39
    s_waitcnt vmcnt(4)
    buffer_load_dwordx4 v[72:75], v1, s[48:51], s89 offen offset:2048 nt
    s_waitcnt vmcnt(4)
    buffer_load_dwordx4 v[76:79], v1, s[48:51], s89 offen offset:3072 nt
    v_perm_b32 v56, v228, v224, s84
    v_perm_b32 v57, v228, v224, s85
    v_perm_b32 v58, v229, v225, s84
    v_perm_b32 v59, v229, v225, s85
    v_perm_b32 v60, v230, v226, s84
    v_perm_b32 v61, v230, v226, s85
    v_perm_b32 v62, v231, v227, s84
    v_perm_b32 v63, v231, v227, s85
    s_waitcnt lgkmcnt(12)
    v_dot2_f32_bf16 v32, v56, v180, v32
    v_dot2_f32_bf16 v33, v57, v180, v33
    v_dot2_f32_bf16 v34, v58, v180, v34
    v_dot2_f32_bf16 v35, v59, v180, v35
    v_dot2_f32_bf16 v36, v60, v180, v36
    v_dot2_f32_bf16 v37, v61, v180, v37
    v_dot2_f32_bf16 v38, v62, v180, v38
    v_dot2_f32_bf16 v39, v63, v180, v39
    s_waitcnt vmcnt(4)
    buffer_load_dwordx4 v[80:83], v1, s[48:51], s90 offen offset:0 nt
    s_waitcnt vmcnt(4)
    buffer_load_dwordx4 v[84:87], v1, s[48:51], s90 offen offset:1024 nt
    v_perm_b32 v56, v236, v232, s84
    v_perm_b32 v57, v236, v232, s85
    v_perm_b32 v58, v237, v233, s84
    v_perm_b32 v59, v237, v233, s85
    v_perm_b32 v60, v238, v234, s84
    v_perm_b32 v61, v238, v234, s85
    v_perm_b32 v62, v239, v235, s84
    v_perm_b32 v63, v239, v235, s85
    s_waitcnt lgkmcnt(11)
    v_dot2_f32_bf16 v32, v56, v181, v32
    v_dot2_f32_bf16 v33, v57, v181, v33
    v_dot2_f32_bf16 v34, v58, v181, v34
    v_dot2_f32_bf16 v35, v59, v181, v35
    v_dot2_f32_bf16 v36, v60, v181, v36
    v_dot2_f32_bf16 v37, v61, v181, v37
    v_dot2_f32_bf16 v38, v62, v181, v38
    v_dot2_f32_bf16 v39, v63, v181, v39
    s_waitcnt vmcnt(4)
    buffer_load_dwordx4 v[88:91], v1, s[48:51], s90 offen offset:2048 nt
    s_waitcnt vmcnt(4)
    buffer_load_dwordx4 v[92:95], v1, s[48:51], s90 offen offset:3072 nt
    v_perm_b32 v56, v244, v240, s84
    v_perm_b32 v57, v244, v240, s85
    v_perm_b32 v58, v245, v241, s84
    v_perm_b32 v59, v245, v241, s85
    v_perm_b32 v60, v246, v242, s84
    v_perm_b32 v61, v246, v242, s85
    v_perm_b32 v62, v247, v243, s84
    v_perm_b32 v63, v247, v243, s85
    s_waitcnt lgkmcnt(10)
    v_dot2_f32_bf16 v32, v56, v182, v32
    v_dot2_f32_bf16 v33, v57, v182, v33
    v_dot2_f32_bf16 v34, v58, v182, v34
    v_dot2_f32_bf16 v35, v59, v182, v35
    v_dot2_f32_bf16 v36, v60, v182, v36
    v_dot2_f32_bf16 v37, v61, v182, v37
    v_dot2_f32_bf16 v38, v62, v182, v38
    v_dot2_f32_bf16 v39, v63, v182, v39
    s_waitcnt vmcnt(4)
    buffer_load_dwordx4 v[96:99], v1, s[48:51], s91 offen offset:0 nt
    s_waitcnt vmcnt(4)
    buffer_load_dwordx4 v[100:103], v1, s[48:51], s91 offen offset:1024 nt
    v_perm_b32 v56, v252, v248, s84
    v_perm_b32 v57, v252, v248, s85
    v_perm_b32 v58, v253, v249, s84
    v_perm_b32 v59, v253, v249, s85
    v_perm_b32 v60, v254, v250, s84
    v_perm_b32 v61, v254, v250, s85
    v_perm_b32 v62, v255, v251, s84
    v_perm_b32 v63, v255, v251, s85
    s_waitcnt lgkmcnt(9)
    v_dot2_f32_bf16 v32, v56, v183, v32
    v_dot2_f32_bf16 v33, v57, v183, v33
    v_dot2_f32_bf16 v34, v58, v183, v34
    v_dot2_f32_bf16 v35, v59, v183, v35
    v_dot2_f32_bf16 v36, v60, v183, v36
    v_dot2_f32_bf16 v37, v61, v183, v37
    v_dot2_f32_bf16 v38, v62, v183, v38
    v_dot2_f32_bf16 v39, v63, v183, v39
    s_waitcnt vmcnt(4)
    buffer_load_dwordx4 v[104:107], v1, s[48:51], s91 offen offset:2048 nt
    s_waitcnt vmcnt(4)
    buffer_load_dwordx4 v[108:111], v1, s[48:51], s91 offen offset:3072 nt
    v_perm_b32 v56, v68, v64, s84
    v_perm_b32 v57, v68, v64, s85
    v_perm_b32 v58, v69, v65, s84
    v_perm_b32 v59, v69, v65, s85
    v_perm_b32 v60, v70, v66, s84
    v_perm_b32 v61, v70, v66, s85
    v_perm_b32 v62, v71, v67, s84
    v_perm_b32 v63, v71, v67, s85
    s_waitcnt lgkmcnt(8)
    v_dot2_f32_bf16 v32, v56, v184, v32
    v_dot2_f32_bf16 v33, v57, v184, v33
    v_dot2_f32_bf16 v34, v58, v184, v34
    v_dot2_f32_bf16 v35, v59, v184, v35
    v_dot2_f32_bf16 v36, v60, v184, v36
    v_dot2_f32_bf16 v37, v61, v184, v37
    v_dot2_f32_bf16 v38, v62, v184, v38
    v_dot2_f32_bf16 v39, v63, v184, v39
    v_lshrrev_b32 v13, 3, v0
    v_and_b32 v14, 7, v0
    v_lshlrev_b32 v14, 4, v14
    v_mul_u32_u24 v15, 3584, v13
    v_add_u32 v15, v15, v14
    buffer_load_dwordx4 v[144:147], v15, s[68:71], 0 offen offset:0 nt
    buffer_load_dwordx4 v[148:151], v15, s[68:71], 0 offen offset:896 nt
    buffer_load_dwordx4 v[152:155], v15, s[68:71], 0 offen offset:1792 nt
    buffer_load_dwordx4 v[156:159], v15, s[68:71], 0 offen offset:2688 nt
    s_waitcnt vmcnt(4)
    buffer_load_dwordx4 v[112:115], v1, s[48:51], s92 offen offset:0 nt
    s_waitcnt vmcnt(4)
    buffer_load_dwordx4 v[116:119], v1, s[48:51], s92 offen offset:1024 nt
    v_perm_b32 v56, v76, v72, s84
    v_perm_b32 v57, v76, v72, s85
    v_perm_b32 v58, v77, v73, s84
    v_perm_b32 v59, v77, v73, s85
    v_perm_b32 v60, v78, v74, s84
    v_perm_b32 v61, v78, v74, s85
    v_perm_b32 v62, v79, v75, s84
    v_perm_b32 v63, v79, v75, s85
    s_waitcnt lgkmcnt(7)
    v_dot2_f32_bf16 v32, v56, v185, v32
    v_dot2_f32_bf16 v33, v57, v185, v33
    v_dot2_f32_bf16 v34, v58, v185, v34
    v_dot2_f32_bf16 v35, v59, v185, v35
    v_dot2_f32_bf16 v36, v60, v185, v36
    v_dot2_f32_bf16 v37, v61, v185, v37
    v_dot2_f32_bf16 v38, v62, v185, v38
    v_dot2_f32_bf16 v39, v63, v185, v39
    s_waitcnt vmcnt(4)
    buffer_load_dwordx4 v[120:123], v1, s[48:51], s92 offen offset:2048 nt
    s_waitcnt vmcnt(4)
    buffer_load_dwordx4 v[124:127], v1, s[48:51], s92 offen offset:3072 nt
    v_perm_b32 v56, v84, v80, s84
    v_perm_b32 v57, v84, v80, s85
    v_perm_b32 v58, v85, v81, s84
    v_perm_b32 v59, v85, v81, s85
    v_perm_b32 v60, v86, v82, s84
    v_perm_b32 v61, v86, v82, s85
    v_perm_b32 v62, v87, v83, s84
    v_perm_b32 v63, v87, v83, s85
    s_waitcnt lgkmcnt(6)
    v_dot2_f32_bf16 v32, v56, v186, v32
    v_dot2_f32_bf16 v33, v57, v186, v33
    v_dot2_f32_bf16 v34, v58, v186, v34
    v_dot2_f32_bf16 v35, v59, v186, v35
    v_dot2_f32_bf16 v36, v60, v186, v36
    v_dot2_f32_bf16 v37, v61, v186, v37
    v_dot2_f32_bf16 v38, v62, v186, v38
    v_dot2_f32_bf16 v39, v63, v186, v39
    v_perm_b32 v56, v92, v88, s84
    v_perm_b32 v57, v92, v88, s85
    v_perm_b32 v58, v93, v89, s84
    v_perm_b32 v59, v93, v89, s85
    v_perm_b32 v60, v94, v90, s84
    v_perm_b32 v61, v94, v90, s85
    v_perm_b32 v62, v95, v91, s84
    v_perm_b32 v63, v95, v91, s85
    s_waitcnt lgkmcnt(5)
    v_dot2_f32_bf16 v32, v56, v187, v32
    v_dot2_f32_bf16 v33, v57, v187, v33
    v_dot2_f32_bf16 v34, v58, v187, v34
    v_dot2_f32_bf16 v35, v59, v187, v35
    v_dot2_f32_bf16 v36, v60, v187, v36
    v_dot2_f32_bf16 v37, v61, v187, v37
    v_dot2_f32_bf16 v38, v62, v187, v38
    v_dot2_f32_bf16 v39, v63, v187, v39
    v_perm_b32 v56, v100, v96, s84
    v_perm_b32 v57, v100, v96, s85
    v_perm_b32 v58, v101, v97, s84
    v_perm_b32 v59, v101, v97, s85
    v_perm_b32 v60, v102, v98, s84
    v_perm_b32 v61, v102, v98, s85
    v_perm_b32 v62, v103, v99, s84
    v_perm_b32 v63, v103, v99, s85
    s_waitcnt lgkmcnt(4)
    v_dot2_f32_bf16 v32, v56, v188, v32
    v_dot2_f32_bf16 v33, v57, v188, v33
    v_dot2_f32_bf16 v34, v58, v188, v34
    v_dot2_f32_bf16 v35, v59, v188, v35
    v_dot2_f32_bf16 v36, v60, v188, v36
    v_dot2_f32_bf16 v37, v61, v188, v37
    v_dot2_f32_bf16 v38, v62, v188, v38
    v_dot2_f32_bf16 v39, v63, v188, v39
    v_perm_b32 v56, v108, v104, s84
    v_perm_b32 v57, v108, v104, s85
    v_perm_b32 v58, v109, v105, s84
    v_perm_b32 v59, v109, v105, s85
    v_perm_b32 v60, v110, v106, s84
    v_perm_b32 v61, v110, v106, s85
    v_perm_b32 v62, v111, v107, s84
    v_perm_b32 v63, v111, v107, s85
    s_waitcnt lgkmcnt(3)
    v_dot2_f32_bf16 v32, v56, v189, v32
    v_dot2_f32_bf16 v33, v57, v189, v33
    v_dot2_f32_bf16 v34, v58, v189, v34
    v_dot2_f32_bf16 v35, v59, v189, v35
    v_dot2_f32_bf16 v36, v60, v189, v36
    v_dot2_f32_bf16 v37, v61, v189, v37
    v_dot2_f32_bf16 v38, v62, v189, v38
    v_dot2_f32_bf16 v39, v63, v189, v39
    s_waitcnt vmcnt(2)
    v_perm_b32 v56, v116, v112, s84
    v_perm_b32 v57, v116, v112, s85
    v_perm_b32 v58, v117, v113, s84
    v_perm_b32 v59, v117, v113, s85
    v_perm_b32 v60, v118, v114, s84
    v_perm_b32 v61, v118, v114, s85
    v_perm_b32 v62, v119, v115, s84
    v_perm_b32 v63, v119, v115, s85
    s_waitcnt lgkmcnt(2)
    v_dot2_f32_bf16 v32, v56, v190, v32
    v_dot2_f32_bf16 v33, v57, v190, v33
    v_dot2_f32_bf16 v34, v58, v190, v34
    v_dot2_f32_bf16 v35, v59, v190, v35
    v_dot2_f32_bf16 v36, v60, v190, v36
    v_dot2_f32_bf16 v37, v61, v190, v37
    v_dot2_f32_bf16 v38, v62, v190, v38
    v_dot2_f32_bf16 v39, v63, v190, v39
    s_waitcnt vmcnt(0)
    v_perm_b32 v56, v124, v120, s84
    v_perm_b32 v57, v124, v120, s85
    v_perm_b32 v58, v125, v121, s84
    v_perm_b32 v59, v125, v121, s85
    v_perm_b32 v60, v126, v122, s84
    v_perm_b32 v61, v126, v122, s85
    v_perm_b32 v62, v127, v123, s84
    v_perm_b32 v63, v127, v123, s85
    s_waitcnt lgkmcnt(1)
    v_dot2_f32_bf16 v32, v56, v191, v32
    v_dot2_f32_bf16 v33, v57, v191, v33
    v_dot2_f32_bf16 v34, v58, v191, v34
    v_dot2_f32_bf16 v35, v59, v191, v35
    v_dot2_f32_bf16 v36, v60, v191, v36
    v_dot2_f32_bf16 v37, v61, v191, v37
    v_dot2_f32_bf16 v38, v62, v191, v38
    v_dot2_f32_bf16 v39, v63, v191, v39
    v_permlane32_swap_b32 v32, v36
    v_permlane32_swap_b32 v33, v37
    v_permlane32_swap_b32 v34, v38
    v_permlane32_swap_b32 v35, v39
    v_add_f32 v44, v32, v36
    v_add_f32 v45, v33, v37
    v_add_f32 v46, v34, v38
    v_add_f32 v47, v35, v39
    ds_write_b128 v10, v[44:47]
    v_and_b32 v13, 7, v0
    v_lshlrev_b32 v13, 2, v13
    s_waitcnt lgkmcnt(0)
    s_barrier
    ds_read_b32 v52, v13 offset:8320
    ds_read_b32 v55, v13 offset:8352
    ds_read_b128 v[48:51], v12
    s_waitcnt lgkmcnt(2)
    v_max_f32_dpp v54, v52, v52 quad_perm:[1,0,3,2] row_mask:0xf bank_mask:0xf
    s_nop 1
    v_max_f32_dpp v54, v54, v54 quad_perm:[2,3,0,1] row_mask:0xf bank_mask:0xf
    s_nop 1
    v_max_f32_dpp v54, v54, v54 row_half_mirror row_mask:0xf bank_mask:0xf
    v_sub_f32 v53, v52, v54
    v_mul_f32 v53, 0x3db8aa3b, v53
    v_exp_f32 v53, v53
    s_waitcnt lgkmcnt(1)
    v_mul_f32 v55, v55, v53
    s_waitcnt lgkmcnt(0)
    v_mul_f32 v48, v48, v53
    v_mul_f32 v49, v49, v53
    v_mul_f32 v50, v50, v53
    v_mul_f32 v51, v51, v53
    v_add_f32_dpp v55, v55, v55 quad_perm:[1,0,3,2] row_mask:0xf bank_mask:0xf
    v_add_f32_dpp v48, v48, v48 quad_perm:[1,0,3,2] row_mask:0xf bank_mask:0xf
    v_add_f32_dpp v49, v49, v49 quad_perm:[1,0,3,2] row_mask:0xf bank_mask:0xf
    v_add_f32_dpp v50, v50, v50 quad_perm:[1,0,3,2] row_mask:0xf bank_mask:0xf
    v_add_f32_dpp v51, v51, v51 quad_perm:[1,0,3,2] row_mask:0xf bank_mask:0xf
    v_add_f32_dpp v55, v55, v55 quad_perm:[2,3,0,1] row_mask:0xf bank_mask:0xf
    v_add_f32_dpp v48, v48, v48 quad_perm:[2,3,0,1] row_mask:0xf bank_mask:0xf
    v_add_f32_dpp v49, v49, v49 quad_perm:[2,3,0,1] row_mask:0xf bank_mask:0xf
    v_add_f32_dpp v50, v50, v50 quad_perm:[2,3,0,1] row_mask:0xf bank_mask:0xf
    v_add_f32_dpp v51, v51, v51 quad_perm:[2,3,0,1] row_mask:0xf bank_mask:0xf
    v_add_f32_dpp v55, v55, v55 row_half_mirror row_mask:0xf bank_mask:0xf
    v_add_f32_dpp v48, v48, v48 row_half_mirror row_mask:0xf bank_mask:0xf
    v_add_f32_dpp v49, v49, v49 row_half_mirror row_mask:0xf bank_mask:0xf
    v_add_f32_dpp v50, v50, v50 row_half_mirror row_mask:0xf bank_mask:0xf
    v_add_f32_dpp v51, v51, v51 row_half_mirror row_mask:0xf bank_mask:0xf
    s_mov_b32 exec_lo, 0x01010101
    s_mov_b32 exec_hi, 0x01010101
    global_store_dwordx4 v3, v[48:51], s[42:43] sc1
    s_mov_b64 exec, 1
    global_store_dwordx2 v4, v[54:55], s[42:43] sc1
    s_mov_b64 exec, -1
    v_perm_b32 v128, v148, v144, s84
    v_perm_b32 v148, v148, v144, s85
    v_perm_b32 v144, v149, v145, s84
    v_perm_b32 v149, v149, v145, s85
    v_perm_b32 v145, v150, v146, s84
    v_perm_b32 v150, v150, v146, s85
    v_perm_b32 v146, v151, v147, s84
    v_perm_b32 v151, v151, v147, s85
    v_perm_b32 v147, v156, v152, s84
    v_perm_b32 v156, v156, v152, s85
    v_perm_b32 v152, v157, v153, s84
    v_perm_b32 v157, v157, v153, s85
    v_perm_b32 v153, v158, v154, s84
    v_perm_b32 v158, v158, v154, s85
    v_perm_b32 v154, v159, v155, s84
    v_perm_b32 v159, v159, v155, s85
    v_lshrrev_b32 v13, 3, v0
    v_lshlrev_b32 v13, 4, v13
    s_barrier
    ds_read_b128 v[72:75], v13 offset:8384
    s_waitcnt lgkmcnt(0)
    v_dot2_f32_bf16 v32, v128, v72, 0
    v_dot2_f32_bf16 v33, v148, v72, 0
    v_dot2_f32_bf16 v34, v144, v72, 0
    v_dot2_f32_bf16 v35, v149, v72, 0
    v_dot2_f32_bf16 v36, v145, v72, 0
    v_dot2_f32_bf16 v37, v150, v72, 0
    v_dot2_f32_bf16 v38, v146, v72, 0
    v_dot2_f32_bf16 v39, v151, v72, 0
    v_dot2_f32_bf16 v40, v128, v74, 0
    v_dot2_f32_bf16 v41, v148, v74, 0
    v_dot2_f32_bf16 v42, v144, v74, 0
    v_dot2_f32_bf16 v43, v149, v74, 0
    v_dot2_f32_bf16 v44, v145, v74, 0
    v_dot2_f32_bf16 v45, v150, v74, 0
    v_dot2_f32_bf16 v46, v146, v74, 0
    v_dot2_f32_bf16 v47, v151, v74, 0
    v_dot2_f32_bf16 v32, v147, v73, v32
    v_dot2_f32_bf16 v33, v156, v73, v33
    v_dot2_f32_bf16 v34, v152, v73, v34
    v_dot2_f32_bf16 v35, v157, v73, v35
    v_dot2_f32_bf16 v36, v153, v73, v36
    v_dot2_f32_bf16 v37, v158, v73, v37
    v_dot2_f32_bf16 v38, v154, v73, v38
    v_dot2_f32_bf16 v39, v159, v73, v39
    v_dot2_f32_bf16 v40, v147, v75, v40
    v_dot2_f32_bf16 v41, v156, v75, v41
    v_dot2_f32_bf16 v42, v152, v75, v42
    v_dot2_f32_bf16 v43, v157, v75, v43
    v_dot2_f32_bf16 v44, v153, v75, v44
    v_dot2_f32_bf16 v45, v158, v75, v45
    v_dot2_f32_bf16 v46, v154, v75, v46
    v_dot2_f32_bf16 v47, v159, v75, v47
    v_permlane32_swap_b32 v32, v40
    v_permlane32_swap_b32 v33, v41
    v_permlane32_swap_b32 v34, v42
    v_permlane32_swap_b32 v35, v43
    v_permlane32_swap_b32 v36, v44
    v_permlane32_swap_b32 v37, v45
    v_permlane32_swap_b32 v38, v46
    v_permlane32_swap_b32 v39, v47
    v_pk_add_f32 v[32:33], v[32:33], v[40:41]
    v_pk_add_f32 v[36:37], v[36:37], v[44:45]
    v_pk_add_f32 v[34:35], v[34:35], v[42:43]
    v_pk_add_f32 v[38:39], v[38:39], v[46:47]
    v_permlane16_swap_b32 v32, v36
    v_permlane16_swap_b32 v33, v37
    v_permlane16_swap_b32 v34, v38
    v_permlane16_swap_b32 v35, v39
    v_pk_add_f32 v[32:33], v[32:33], v[36:37]
    v_pk_add_f32 v[34:35], v[34:35], v[38:39]
    s_nop 0
    v_add_f32_dpp v32, v32, v32 row_ror:8 row_mask:0xf bank_mask:0xf
    v_add_f32_dpp v33, v33, v33 row_ror:8 row_mask:0xf bank_mask:0xf
    v_add_f32_dpp v34, v34, v34 row_ror:8 row_mask:0xf bank_mask:0xf
    v_add_f32_dpp v35, v35, v35 row_ror:8 row_mask:0xf bank_mask:0xf
    s_mov_b32 exec_lo, 0x00ff00ff
    s_mov_b32 exec_hi, 0x00ff00ff
    global_store_dwordx4 v5, v[32:35], s[42:43] sc1
    s_mov_b64 exec, -1
    s_branch L_FIN
L_PWAVE:
    s_cmp_eq_u32 s60, 0
    s_cbranch_scc1 L_PA
    v_perm_b32 v56, v196, v192, s84
    v_perm_b32 v57, v196, v192, s85
    v_perm_b32 v58, v197, v193, s84
    v_perm_b32 v59, v197, v193, s85
    v_perm_b32 v60, v198, v194, s84
    v_perm_b32 v61, v198, v194, s85
    v_perm_b32 v62, v199, v195, s84
    v_perm_b32 v63, v199, v195, s85
    v_dot2_f32_bf16 v32, v56, v176, 0
    v_dot2_f32_bf16 v33, v57, v176, 0
    v_dot2_f32_bf16 v34, v58, v176, 0
    v_dot2_f32_bf16 v35, v59, v176, 0
    v_dot2_f32_bf16 v36, v60, v176, 0
    v_dot2_f32_bf16 v37, v61, v176, 0
    v_dot2_f32_bf16 v38, v62, v176, 0
    v_dot2_f32_bf16 v39, v63, v176, 0
    v_perm_b32 v56, v204, v200, s84
    v_perm_b32 v57, v204, v200, s85
    v_perm_b32 v58, v205, v201, s84
    v_perm_b32 v59, v205, v201, s85
    v_perm_b32 v60, v206, v202, s84
    v_perm_b32 v61, v206, v202, s85
    v_perm_b32 v62, v207, v203, s84
    v_perm_b32 v63, v207, v203, s85
    v_dot2_f32_bf16 v32, v56, v177, v32
    v_dot2_f32_bf16 v33, v57, v177, v33
    v_dot2_f32_bf16 v34, v58, v177, v34
    v_dot2_f32_bf16 v35, v59, v177, v35
    v_dot2_f32_bf16 v36, v60, v177, v36
    v_dot2_f32_bf16 v37, v61, v177, v37
    v_dot2_f32_bf16 v38, v62, v177, v38
    v_dot2_f32_bf16 v39, v63, v177, v39
    v_perm_b32 v56, v212, v208, s84
    v_perm_b32 v57, v212, v208, s85
    v_perm_b32 v58, v213, v209, s84
    v_perm_b32 v59, v213, v209, s85
    v_perm_b32 v60, v214, v210, s84
    v_perm_b32 v61, v214, v210, s85
    v_perm_b32 v62, v215, v211, s84
    v_perm_b32 v63, v215, v211, s85
    v_dot2_f32_bf16 v32, v56, v178, v32
    v_dot2_f32_bf16 v33, v57, v178, v33
    v_dot2_f32_bf16 v34, v58, v178, v34
    v_dot2_f32_bf16 v35, v59, v178, v35
    v_dot2_f32_bf16 v36, v60, v178, v36
    v_dot2_f32_bf16 v37, v61, v178, v37
    v_dot2_f32_bf16 v38, v62, v178, v38
    v_dot2_f32_bf16 v39, v63, v178, v39
    s_min_u32 s94, s8, 111
    s_lshr_b32 s95, s94, 2
    s_lshl_b32 s95, s95, 2
    s_add_u32 s95, s95, 0
    v_mov_b32 v129, s95
    global_load_dword v128, v129, s[40:41] sc1
    s_waitcnt vmcnt(4)
    buffer_load_dwordx4 v[64:67], v1, s[48:51], s89 offen offset:0 nt
    s_waitcnt vmcnt(4)
    buffer_load_dwordx4 v[68:71], v1, s[48:51], s89 offen offset:1024 nt
    v_perm_b32 v56, v220, v216, s84
    v_perm_b32 v57, v220, v216, s85
    v_perm_b32 v58, v221, v217, s84
    v_perm_b32 v59, v221, v217, s85
    v_perm_b32 v60, v222, v218, s84
    v_perm_b32 v61, v222, v218, s85
    v_perm_b32 v62, v223, v219, s84
    v_perm_b32 v63, v223, v219, s85
    s_waitcnt lgkmcnt(13)
    v_dot2_f32_bf16 v32, v56, v179, v32
    v_dot2_f32_bf16 v33, v57, v179, v33
    v_dot2_f32_bf16 v34, v58, v179, v34
    v_dot2_f32_bf16 v35, v59, v179, v35
    v_dot2_f32_bf16 v36, v60, v179, v36
    v_dot2_f32_bf16 v37, v61, v179, v37
    v_dot2_f32_bf16 v38, v62, v179, v38
    v_dot2_f32_bf16 v39, v63, v179, v39
    s_waitcnt vmcnt(4)
    buffer_load_dwordx4 v[72:75], v1, s[48:51], s89 offen offset:2048 nt
    s_waitcnt vmcnt(4)
    buffer_load_dwordx4 v[76:79], v1, s[48:51], s89 offen offset:3072 nt
    v_perm_b32 v56, v228, v224, s84
    v_perm_b32 v57, v228, v224, s85
    v_perm_b32 v58, v229, v225, s84
    v_perm_b32 v59, v229, v225, s85
    v_perm_b32 v60, v230, v226, s84
    v_perm_b32 v61, v230, v226, s85
    v_perm_b32 v62, v231, v227, s84
    v_perm_b32 v63, v231, v227, s85
    s_waitcnt lgkmcnt(12)
    v_dot2_f32_bf16 v32, v56, v180, v32
    v_dot2_f32_bf16 v33, v57, v180, v33
    v_dot2_f32_bf16 v34, v58, v180, v34
    v_dot2_f32_bf16 v35, v59, v180, v35
    v_dot2_f32_bf16 v36, v60, v180, v36
    v_dot2_f32_bf16 v37, v61, v180, v37
    v_dot2_f32_bf16 v38, v62, v180, v38
    v_dot2_f32_bf16 v39, v63, v180, v39
    s_waitcnt vmcnt(4)
    buffer_load_dwordx4 v[80:83], v1, s[48:51], s90 offen offset:0 nt
    s_waitcnt vmcnt(4)
    buffer_load_dwordx4 v[84:87], v1, s[48:51], s90 offen offset:1024 nt
    v_perm_b32 v56, v236, v232, s84
    v_perm_b32 v57, v236, v232, s85
    v_perm_b32 v58, v237, v233, s84
    v_perm_b32 v59, v237, v233, s85
    v_perm_b32 v60, v238, v234, s84
    v_perm_b32 v61, v238, v234, s85
    v_perm_b32 v62, v239, v235, s84
    v_perm_b32 v63, v239, v235, s85
    s_waitcnt lgkmcnt(11)
    v_dot2_f32_bf16 v32, v56, v181, v32
    v_dot2_f32_bf16 v33, v57, v181, v33
    v_dot2_f32_bf16 v34, v58, v181, v34
    v_dot2_f32_bf16 v35, v59, v181, v35
    v_dot2_f32_bf16 v36, v60, v181, v36
    v_dot2_f32_bf16 v37, v61, v181, v37
    v_dot2_f32_bf16 v38, v62, v181, v38
    v_dot2_f32_bf16 v39, v63, v181, v39
    s_min_u32 s94, s8, 111
    s_lshr_b32 s95, s94, 2
    s_lshl_b32 s95, s95, 11
    s_and_b32 s93, s94, 3
    s_lshl_b32 s93, s93, 6
    s_add_u32 s95, s95, s93
    s_add_u32 s95, s95, 1703936
    s_lshl_b32 s94, s94, 5
    s_add_u32 s76, s30, s94
    s_addc_u32 s77, s31, 0
    s_mov_b32 s78, 32
    s_mov_b32 s79, 0x00020000
    v_bfe_u32 v13, v0, 2, 3
    v_and_b32 v14, 3, v0
    v_lshlrev_b32 v13, 8, v13
    v_lshl_add_u32 v13, v14, 4, v13
    v_add_u32 v13, s95, v13
    v_bfe_u32 v15, v0, 4, 1
    v_lshlrev_b32 v15, 2, v15
    v_lshl_add_u32 v14, v14, 3, v15
    v_cmp_ne_u32 vcc, 4, v128
    s_cbranch_vccnz L_HCHK_SLOW
L_HCHK_OK:
    global_load_dwordx4 v[132:135], v13, s[42:43] sc1
    buffer_load_dword v136, v14, s[76:79], 0 offen nt
    s_waitcnt vmcnt(4)
    buffer_load_dwordx4 v[88:91], v1, s[48:51], s90 offen offset:2048 nt
    s_waitcnt vmcnt(4)
    buffer_load_dwordx4 v[92:95], v1, s[48:51], s90 offen offset:3072 nt
    v_perm_b32 v56, v244, v240, s84
    v_perm_b32 v57, v244, v240, s85
    v_perm_b32 v58, v245, v241, s84
    v_perm_b32 v59, v245, v241, s85
    v_perm_b32 v60, v246, v242, s84
    v_perm_b32 v61, v246, v242, s85
    v_perm_b32 v62, v247, v243, s84
    v_perm_b32 v63, v247, v243, s85
    s_waitcnt lgkmcnt(10)
    v_dot2_f32_bf16 v32, v56, v182, v32
    v_dot2_f32_bf16 v33, v57, v182, v33
    v_dot2_f32_bf16 v34, v58, v182, v34
    v_dot2_f32_bf16 v35, v59, v182, v35
    v_dot2_f32_bf16 v36, v60, v182, v36
    v_dot2_f32_bf16 v37, v61, v182, v37
    v_dot2_f32_bf16 v38, v62, v182, v38
    v_dot2_f32_bf16 v39, v63, v182, v39
    s_waitcnt vmcnt(4)
    buffer_load_dwordx4 v[96:99], v1, s[48:51], s91 offen offset:0 nt
    s_waitcnt vmcnt(4)
    buffer_load_dwordx4 v[100:103], v1, s[48:51], s91 offen offset:1024 nt
    v_perm_b32 v56, v252, v248, s84
    v_perm_b32 v57, v252, v248, s85
    v_perm_b32 v58, v253, v249, s84
    v_perm_b32 v59, v253, v249, s85
    v_perm_b32 v60, v254, v250, s84
    v_perm_b32 v61, v254, v250, s85
    v_perm_b32 v62, v255, v251, s84
    v_perm_b32 v63, v255, v251, s85
    s_waitcnt lgkmcnt(9)
    v_dot2_f32_bf16 v32, v56, v183, v32
    v_dot2_f32_bf16 v33, v57, v183, v33
    v_dot2_f32_bf16 v34, v58, v183, v34
    v_dot2_f32_bf16 v35, v59, v183, v35
    v_dot2_f32_bf16 v36, v60, v183, v36
    v_dot2_f32_bf16 v37, v61, v183, v37
    v_dot2_f32_bf16 v38, v62, v183, v38
    v_dot2_f32_bf16 v39, v63, v183, v39
    s_waitcnt vmcnt(4)
    buffer_load_dwordx4 v[104:107], v1, s[48:51], s91 offen offset:2048 nt
    s_waitcnt vmcnt(4)
    buffer_load_dwordx4 v[108:111], v1, s[48:51], s91 offen offset:3072 nt
    v_perm_b32 v56, v68, v64, s84
    v_perm_b32 v57, v68, v64, s85
    v_perm_b32 v58, v69, v65, s84
    v_perm_b32 v59, v69, v65, s85
    v_perm_b32 v60, v70, v66, s84
    v_perm_b32 v61, v70, v66, s85
    v_perm_b32 v62, v71, v67, s84
    v_perm_b32 v63, v71, v67, s85
    s_waitcnt lgkmcnt(8)
    v_dot2_f32_bf16 v32, v56, v184, v32
    v_dot2_f32_bf16 v33, v57, v184, v33
    v_dot2_f32_bf16 v34, v58, v184, v34
    v_dot2_f32_bf16 v35, v59, v184, v35
    v_dot2_f32_bf16 v36, v60, v184, v36
    v_dot2_f32_bf16 v37, v61, v184, v37
    v_dot2_f32_bf16 v38, v62, v184, v38
    v_dot2_f32_bf16 v39, v63, v184, v39
    s_waitcnt vmcnt(4)
    buffer_load_dwordx4 v[112:115], v1, s[48:51], s92 offen offset:0 nt
    s_waitcnt vmcnt(4)
    buffer_load_dwordx4 v[116:119], v1, s[48:51], s92 offen offset:1024 nt
    v_perm_b32 v56, v76, v72, s84
    v_perm_b32 v57, v76, v72, s85
    v_perm_b32 v58, v77, v73, s84
    v_perm_b32 v59, v77, v73, s85
    v_perm_b32 v60, v78, v74, s84
    v_perm_b32 v61, v78, v74, s85
    v_perm_b32 v62, v79, v75, s84
    v_perm_b32 v63, v79, v75, s85
    s_waitcnt lgkmcnt(7)
    v_dot2_f32_bf16 v32, v56, v185, v32
    v_dot2_f32_bf16 v33, v57, v185, v33
    v_dot2_f32_bf16 v34, v58, v185, v34
    v_dot2_f32_bf16 v35, v59, v185, v35
    v_dot2_f32_bf16 v36, v60, v185, v36
    v_dot2_f32_bf16 v37, v61, v185, v37
    v_dot2_f32_bf16 v38, v62, v185, v38
    v_dot2_f32_bf16 v39, v63, v185, v39
    v_add_f32_dpp v132, v132, v132 row_ror:8 row_mask:0xf bank_mask:0xf
    v_add_f32_dpp v133, v133, v133 row_ror:8 row_mask:0xf bank_mask:0xf
    v_add_f32_dpp v134, v134, v134 row_ror:8 row_mask:0xf bank_mask:0xf
    v_add_f32_dpp v135, v135, v135 row_ror:8 row_mask:0xf bank_mask:0xf
    s_nop 0
    v_permlane16_swap_b32 v132, v134
    v_permlane16_swap_b32 v133, v135
    v_add_f32 v132, v132, v134
    v_add_f32 v133, v133, v135
    v_cvt_pk_bf16_f32 v48, v132, v133
    v_lshlrev_b32 v132, 16, v48
    v_and_b32 v133, 0xffff0000, v48
    v_lshlrev_b32 v48, 16, v136
    v_and_b32 v49, 0xffff0000, v136
    v_add_f32 v132, v132, v48
    v_add_f32 v133, v133, v49
    v_cvt_pk_bf16_f32 v48, v132, v133
    v_lshlrev_b32 v132, 16, v48
    v_and_b32 v133, 0xffff0000, v48
    s_mov_b32 s94, 0xbdd2d3e8
    s_mov_b32 s95, 0xc0135761
    v_mul_f32 v48, v132, v132
    v_mul_f32 v49, v133, v133
    v_mul_f32 v48, s94, v48
    v_mul_f32 v49, s94, v49
    v_add_f32 v48, s95, v48
    v_add_f32 v49, s95, v49
    v_mul_f32 v48, v48, v132
    v_mul_f32 v49, v49, v133
    v_exp_f32 v48, v48
    v_exp_f32 v49, v49
    v_add_f32 v48, 1.0, v48
    v_add_f32 v49, 1.0, v49
    v_rcp_f32 v48, v48
    v_rcp_f32 v49, v49
    v_mul_f32 v132, v132, v48
    v_mul_f32 v133, v133, v49
    v_cvt_pk_bf16_f32 v132, v132, v133
    v_and_b32 v13, 3, v0
    v_lshlrev_b32 v13, 4, v13
    v_bfe_u32 v14, v0, 2, 1
    v_lshl_add_u32 v13, v14, 3, v13
    v_bfe_u32 v14, v0, 3, 1
    v_lshl_add_u32 v13, v14, 6, v13
    v_bfe_u32 v14, v0, 4, 1
    v_lshl_add_u32 v13, v14, 2, v13
    s_mov_b32 exec_lo, 0xff00ff00
    s_mov_b32 exec_hi, 0
    v_mov_b32 v132, 0
    s_mov_b32 exec_lo, -1
    ds_write_b32 v13, v132 offset:8384
    s_mov_b64 exec, -1
    s_waitcnt vmcnt(4)
    buffer_load_dwordx4 v[120:123], v1, s[48:51], s92 offen offset:2048 nt
    s_waitcnt vmcnt(4)
    buffer_load_dwordx4 v[124:127], v1, s[48:51], s92 offen offset:3072 nt
    v_perm_b32 v56, v84, v80, s84
    v_perm_b32 v57, v84, v80, s85
    v_perm_b32 v58, v85, v81, s84
    v_perm_b32 v59, v85, v81, s85
    v_perm_b32 v60, v86, v82, s84
    v_perm_b32 v61, v86, v82, s85
    v_perm_b32 v62, v87, v83, s84
    v_perm_b32 v63, v87, v83, s85
    s_waitcnt lgkmcnt(7)
    v_dot2_f32_bf16 v32, v56, v186, v32
    v_dot2_f32_bf16 v33, v57, v186, v33
    v_dot2_f32_bf16 v34, v58, v186, v34
    v_dot2_f32_bf16 v35, v59, v186, v35
    v_dot2_f32_bf16 v36, v60, v186, v36
    v_dot2_f32_bf16 v37, v61, v186, v37
    v_dot2_f32_bf16 v38, v62, v186, v38
    v_dot2_f32_bf16 v39, v63, v186, v39
    v_perm_b32 v56, v92, v88, s84
    v_perm_b32 v57, v92, v88, s85
    v_perm_b32 v58, v93, v89, s84
    v_perm_b32 v59, v93, v89, s85
    v_perm_b32 v60, v94, v90, s84
    v_perm_b32 v61, v94, v90, s85
    v_perm_b32 v62, v95, v91, s84
    v_perm_b32 v63, v95, v91, s85
    s_waitcnt lgkmcnt(6)
    v_dot2_f32_bf16 v32, v56, v187, v32
    v_dot2_f32_bf16 v33, v57, v187, v33
    v_dot2_f32_bf16 v34, v58, v187, v34
    v_dot2_f32_bf16 v35, v59, v187, v35
    v_dot2_f32_bf16 v36, v60, v187, v36
    v_dot2_f32_bf16 v37, v61, v187, v37
    v_dot2_f32_bf16 v38, v62, v187, v38
    v_dot2_f32_bf16 v39, v63, v187, v39
    v_perm_b32 v56, v100, v96, s84
    v_perm_b32 v57, v100, v96, s85
    v_perm_b32 v58, v101, v97, s84
    v_perm_b32 v59, v101, v97, s85
    v_perm_b32 v60, v102, v98, s84
    v_perm_b32 v61, v102, v98, s85
    v_perm_b32 v62, v103, v99, s84
    v_perm_b32 v63, v103, v99, s85
    s_waitcnt lgkmcnt(5)
    v_dot2_f32_bf16 v32, v56, v188, v32
    v_dot2_f32_bf16 v33, v57, v188, v33
    v_dot2_f32_bf16 v34, v58, v188, v34
    v_dot2_f32_bf16 v35, v59, v188, v35
    v_dot2_f32_bf16 v36, v60, v188, v36
    v_dot2_f32_bf16 v37, v61, v188, v37
    v_dot2_f32_bf16 v38, v62, v188, v38
    v_dot2_f32_bf16 v39, v63, v188, v39
    s_waitcnt vmcnt(4)
    v_perm_b32 v56, v108, v104, s84
    v_perm_b32 v57, v108, v104, s85
    v_perm_b32 v58, v109, v105, s84
    v_perm_b32 v59, v109, v105, s85
    v_perm_b32 v60, v110, v106, s84
    v_perm_b32 v61, v110, v106, s85
    v_perm_b32 v62, v111, v107, s84
    v_perm_b32 v63, v111, v107, s85
    s_waitcnt lgkmcnt(4)
    v_dot2_f32_bf16 v32, v56, v189, v32
    v_dot2_f32_bf16 v33, v57, v189, v33
    v_dot2_f32_bf16 v34, v58, v189, v34
    v_dot2_f32_bf16 v35, v59, v189, v35
    v_dot2_f32_bf16 v36, v60, v189, v36
    v_dot2_f32_bf16 v37, v61, v189, v37
    v_dot2_f32_bf16 v38, v62, v189, v38
    v_dot2_f32_bf16 v39, v63, v189, v39
    s_waitcnt vmcnt(2)
    v_perm_b32 v56, v116, v112, s84
    v_perm_b32 v57, v116, v112, s85
    v_perm_b32 v58, v117, v113, s84
    v_perm_b32 v59, v117, v113, s85
    v_perm_b32 v60, v118, v114, s84
    v_perm_b32 v61, v118, v114, s85
    v_perm_b32 v62, v119, v115, s84
    v_perm_b32 v63, v119, v115, s85
    s_waitcnt lgkmcnt(3)
    v_dot2_f32_bf16 v32, v56, v190, v32
    v_dot2_f32_bf16 v33, v57, v190, v33
    v_dot2_f32_bf16 v34, v58, v190, v34
    v_dot2_f32_bf16 v35, v59, v190, v35
    v_dot2_f32_bf16 v36, v60, v190, v36
    v_dot2_f32_bf16 v37, v61, v190, v37
    v_dot2_f32_bf16 v38, v62, v190, v38
    v_dot2_f32_bf16 v39, v63, v190, v39
    s_waitcnt vmcnt(0)
    v_perm_b32 v56, v124, v120, s84
    v_perm_b32 v57, v124, v120, s85
    v_perm_b32 v58, v125, v121, s84
    v_perm_b32 v59, v125, v121, s85
    v_perm_b32 v60, v126, v122, s84
    v_perm_b32 v61, v126, v122, s85
    v_perm_b32 v62, v127, v123, s84
    v_perm_b32 v63, v127, v123, s85
    s_waitcnt lgkmcnt(2)
    v_dot2_f32_bf16 v32, v56, v191, v32
    v_dot2_f32_bf16 v33, v57, v191, v33
    v_dot2_f32_bf16 v34, v58, v191, v34
    v_dot2_f32_bf16 v35, v59, v191, v35
    v_dot2_f32_bf16 v36, v60, v191, v36
    v_dot2_f32_bf16 v37, v61, v191, v37
    v_dot2_f32_bf16 v38, v62, v191, v38
    v_dot2_f32_bf16 v39, v63, v191, v39
    v_permlane32_swap_b32 v32, v36
    v_permlane32_swap_b32 v33, v37
    v_permlane32_swap_b32 v34, v38
    v_permlane32_swap_b32 v35, v39
    v_add_f32 v44, v32, v36
    v_add_f32 v45, v33, v37
    v_add_f32 v46, v34, v38
    v_add_f32 v47, v35, v39
    ds_write_b128 v10, v[44:47]
    v_and_b32 v13, 7, v0
    v_lshlrev_b32 v13, 2, v13
    s_waitcnt lgkmcnt(0)
    s_barrier
    ds_read_b32 v52, v13 offset:8320
    ds_read_b32 v55, v13 offset:8352
    ds_read_b128 v[48:51], v12
    s_waitcnt lgkmcnt(2)
    v_max_f32_dpp v54, v52, v52 quad_perm:[1,0,3,2] row_mask:0xf bank_mask:0xf
    s_nop 1
    v_max_f32_dpp v54, v54, v54 quad_perm:[2,3,0,1] row_mask:0xf bank_mask:0xf
    s_nop 1
    v_max_f32_dpp v54, v54, v54 row_half_mirror row_mask:0xf bank_mask:0xf
    v_sub_f32 v53, v52, v54
    v_mul_f32 v53, 0x3db8aa3b, v53
    v_exp_f32 v53, v53
    s_waitcnt lgkmcnt(1)
    v_mul_f32 v55, v55, v53
    s_waitcnt lgkmcnt(0)
    v_mul_f32 v48, v48, v53
    v_mul_f32 v49, v49, v53
    v_mul_f32 v50, v50, v53
    v_mul_f32 v51, v51, v53
    v_add_f32_dpp v55, v55, v55 quad_perm:[1,0,3,2] row_mask:0xf bank_mask:0xf
    v_add_f32_dpp v48, v48, v48 quad_perm:[1,0,3,2] row_mask:0xf bank_mask:0xf
    v_add_f32_dpp v49, v49, v49 quad_perm:[1,0,3,2] row_mask:0xf bank_mask:0xf
    v_add_f32_dpp v50, v50, v50 quad_perm:[1,0,3,2] row_mask:0xf bank_mask:0xf
    v_add_f32_dpp v51, v51, v51 quad_perm:[1,0,3,2] row_mask:0xf bank_mask:0xf
    v_add_f32_dpp v55, v55, v55 quad_perm:[2,3,0,1] row_mask:0xf bank_mask:0xf
    v_add_f32_dpp v48, v48, v48 quad_perm:[2,3,0,1] row_mask:0xf bank_mask:0xf
    v_add_f32_dpp v49, v49, v49 quad_perm:[2,3,0,1] row_mask:0xf bank_mask:0xf
    v_add_f32_dpp v50, v50, v50 quad_perm:[2,3,0,1] row_mask:0xf bank_mask:0xf
    v_add_f32_dpp v51, v51, v51 quad_perm:[2,3,0,1] row_mask:0xf bank_mask:0xf
    v_add_f32_dpp v55, v55, v55 row_half_mirror row_mask:0xf bank_mask:0xf
    v_add_f32_dpp v48, v48, v48 row_half_mirror row_mask:0xf bank_mask:0xf
    v_add_f32_dpp v49, v49, v49 row_half_mirror row_mask:0xf bank_mask:0xf
    v_add_f32_dpp v50, v50, v50 row_half_mirror row_mask:0xf bank_mask:0xf
    v_add_f32_dpp v51, v51, v51 row_half_mirror row_mask:0xf bank_mask:0xf
    s_mov_b32 exec_lo, 0x01010101
    s_mov_b32 exec_hi, 0x01010101
    global_store_dwordx4 v3, v[48:51], s[42:43] sc1
    s_mov_b64 exec, 1
    global_store_dwordx2 v4, v[54:55], s[42:43] sc1
    s_mov_b64 exec, -1
    s_barrier
    s_branch L_FIN
L_PA:
    v_perm_b32 v56, v196, v192, s84
    v_perm_b32 v57, v196, v192, s85
    v_perm_b32 v58, v197, v193, s84
    v_perm_b32 v59, v197, v193, s85
    v_perm_b32 v60, v198, v194, s84
    v_perm_b32 v61, v198, v194, s85
    v_perm_b32 v62, v199, v195, s84
    v_perm_b32 v63, v199, v195, s85
    v_dot2_f32_bf16 v32, v56, v176, 0
    v_dot2_f32_bf16 v33, v57, v176, 0
    v_dot2_f32_bf16 v34, v58, v176, 0
    v_dot2_f32_bf16 v35, v59, v176, 0
    v_dot2_f32_bf16 v36, v60, v176, 0
    v_dot2_f32_bf16 v37, v61, v176, 0
    v_dot2_f32_bf16 v38, v62, v176, 0
    v_dot2_f32_bf16 v39, v63, v176, 0
    s_mul_i32 s94, s13, 896
    s_cmp_lt_u32 s8, 56
    s_cselect_b32 s95, 896, 0
    s_add_u32 s56, s16, s94
    s_addc_u32 s57, s17, 0
    s_mov_b32 s58, s95
    s_mov_b32 s59, 0x00020000
    s_mov_b32 s72, s36
    s_mov_b32 s73, s37
    s_mov_b32 s74, s95
    s_mov_b32 s75, 0x00020000
    s_mov_b32 s80, s34
    s_mov_b32 s81, s35
    s_mov_b32 s82, s95
    s_mov_b32 s83, 0x00020000
    buffer_load_dwordx4 v[128:131], v1, s[56:59], 0 offen nt
    buffer_load_dwordx4 v[132:135], v1, s[72:75], 0 offen nt
    s_lshl_b32 s94, s12, 5
    v_lshrrev_b32 v13, 4, v0
    v_lshlrev_b32 v13, 3, v13
    buffer_load_dwordx2 v[136:137], v13, s[80:83], s94 offen nt
    v_add_u32 v142, 4096, v8
    v_add_u32 v143, 524288, v8
    v_add_u32 v144, 528384, v8
    v_perm_b32 v56, v204, v200, s84
    v_perm_b32 v57, v204, v200, s85
    v_perm_b32 v58, v205, v201, s84
    v_perm_b32 v59, v205, v201, s85
    v_perm_b32 v60, v206, v202, s84
    v_perm_b32 v61, v206, v202, s85
    v_perm_b32 v62, v207, v203, s84
    v_perm_b32 v63, v207, v203, s85
    v_dot2_f32_bf16 v32, v56, v177, v32
    v_dot2_f32_bf16 v33, v57, v177, v33
    v_dot2_f32_bf16 v34, v58, v177, v34
    v_dot2_f32_bf16 v35, v59, v177, v35
    v_dot2_f32_bf16 v36, v60, v177, v36
    v_dot2_f32_bf16 v37, v61, v177, v37
    v_dot2_f32_bf16 v38, v62, v177, v38
    v_dot2_f32_bf16 v39, v63, v177, v39
    v_perm_b32 v56, v212, v208, s84
    v_perm_b32 v57, v212, v208, s85
    v_perm_b32 v58, v213, v209, s84
    v_perm_b32 v59, v213, v209, s85
    v_perm_b32 v60, v214, v210, s84
    v_perm_b32 v61, v214, v210, s85
    v_perm_b32 v62, v215, v211, s84
    v_perm_b32 v63, v215, v211, s85
    v_dot2_f32_bf16 v32, v56, v178, v32
    v_dot2_f32_bf16 v33, v57, v178, v33
    v_dot2_f32_bf16 v34, v58, v178, v34
    v_dot2_f32_bf16 v35, v59, v178, v35
    v_dot2_f32_bf16 v36, v60, v178, v36
    v_dot2_f32_bf16 v37, v61, v178, v37
    v_dot2_f32_bf16 v38, v62, v178, v38
    v_dot2_f32_bf16 v39, v63, v178, v39
    s_waitcnt vmcnt(4)
    buffer_load_dwordx4 v[64:67], v1, s[48:51], s89 offen offset:0 nt
    s_waitcnt vmcnt(4)
    buffer_load_dwordx4 v[68:71], v1, s[48:51], s89 offen offset:1024 nt
    v_perm_b32 v56, v220, v216, s84
    v_perm_b32 v57, v220, v216, s85
    v_perm_b32 v58, v221, v217, s84
    v_perm_b32 v59, v221, v217, s85
    v_perm_b32 v60, v222, v218, s84
    v_perm_b32 v61, v222, v218, s85
    v_perm_b32 v62, v223, v219, s84
    v_perm_b32 v63, v223, v219, s85
    s_waitcnt lgkmcnt(13)
    v_dot2_f32_bf16 v32, v56, v179, v32
    v_dot2_f32_bf16 v33, v57, v179, v33
    v_dot2_f32_bf16 v34, v58, v179, v34
    v_dot2_f32_bf16 v35, v59, v179, v35
    v_dot2_f32_bf16 v36, v60, v179, v36
    v_dot2_f32_bf16 v37, v61, v179, v37
    v_dot2_f32_bf16 v38, v62, v179, v38
    v_dot2_f32_bf16 v39, v63, v179, v39
    s_mov_b32 s95, 0x3f803f80
    s_waitcnt vmcnt(4)
    v_lshlrev_b32 v48, 16, v128
    s_waitcnt vmcnt(3)
    v_lshlrev_b32 v49, 16, v132
    v_and_b32 v50, 0xffff0000, v128
    v_and_b32 v51, 0xffff0000, v132
    v_mul_f32 v48, v48, v49
    v_mul_f32 v50, v50, v51
    v_cvt_pk_bf16_f32 v48, v48, v50
    v_dot2_f32_bf16 v52, v48, s95, 0
    v_lshlrev_b32 v48, 16, v129
    v_lshlrev_b32 v49, 16, v133
    v_and_b32 v50, 0xffff0000, v129
    v_and_b32 v51, 0xffff0000, v133
    v_mul_f32 v48, v48, v49
    v_mul_f32 v50, v50, v51
    v_cvt_pk_bf16_f32 v48, v48, v50
    v_dot2_f32_bf16 v52, v48, s95, v52
    v_lshlrev_b32 v48, 16, v130
    v_lshlrev_b32 v49, 16, v134
    v_and_b32 v50, 0xffff0000, v130
    v_and_b32 v51, 0xffff0000, v134
    v_mul_f32 v48, v48, v49
    v_mul_f32 v50, v50, v51
    v_cvt_pk_bf16_f32 v48, v48, v50
    v_dot2_f32_bf16 v52, v48, s95, v52
    v_lshlrev_b32 v48, 16, v131
    v_lshlrev_b32 v49, 16, v135
    v_and_b32 v50, 0xffff0000, v131
    v_and_b32 v51, 0xffff0000, v135
    v_mul_f32 v48, v48, v49
    v_mul_f32 v50, v50, v51
    v_cvt_pk_bf16_f32 v48, v48, v50
    v_dot2_f32_bf16 v52, v48, s95, v52
    s_nop 2
    v_add_f32_dpp v52, v52, v52 row_ror:8 row_mask:0xf bank_mask:0xf
    s_nop 1
    v_add_f32_dpp v52, v52, v52 row_ror:4 row_mask:0xf bank_mask:0xf
    s_nop 1
    v_add_f32_dpp v52, v52, v52 row_ror:2 row_mask:0xf bank_mask:0xf
    s_nop 1
    v_add_f32_dpp v52, v52, v52 row_ror:1 row_mask:0xf bank_mask:0xf
    v_mov_b32 v48, v52
    s_nop 1
    v_permlane16_swap_b32 v52, v48
    v_add_f32 v52, v52, v48
    v_mov_b32 v48, v52
    s_nop 1
    v_permlane32_swap_b32 v52, v48
    v_add_f32 v52, v52, v48
    v_cvt_pk_bf16_f32 v52, v52, v52
    v_and_b32 v52, 0xffff0000, v52
    v_mul_f32 v52, 0xbfb8aa3b, v52
    v_exp_f32 v52, v52
    s_nop 0
    v_add_f32 v52, 1.0, v52
    v_rcp_f32 v52, v52
    s_nop 0
    v_cvt_pk_bf16_f32 v140, v52, v52
    v_and_b32 v140, 0xffff0000, v140
    v_sub_f32 v141, 1.0, v140
    v_cvt_pk_bf16_f32 v141, v141, v141
    v_and_b32 v141, 0xffff0000, v141
    s_waitcnt vmcnt(2)
    v_lshlrev_b32 v24, 16, v136
    v_and_b32 v25, 0xffff0000, v136
    v_lshlrev_b32 v26, 16, v137
    v_and_b32 v27, 0xffff0000, v137
    s_waitcnt vmcnt(4)
    buffer_load_dwordx4 v[72:75], v1, s[48:51], s89 offen offset:2048 nt
    s_waitcnt vmcnt(4)
    buffer_load_dwordx4 v[76:79], v1, s[48:51], s89 offen offset:3072 nt
    v_perm_b32 v56, v228, v224, s84
    v_perm_b32 v57, v228, v224, s85
    v_perm_b32 v58, v229, v225, s84
    v_perm_b32 v59, v229, v225, s85
    v_perm_b32 v60, v230, v226, s84
    v_perm_b32 v61, v230, v226, s85
    v_perm_b32 v62, v231, v227, s84
    v_perm_b32 v63, v231, v227, s85
    s_waitcnt lgkmcnt(12)
    v_dot2_f32_bf16 v32, v56, v180, v32
    v_dot2_f32_bf16 v33, v57, v180, v33
    v_dot2_f32_bf16 v34, v58, v180, v34
    v_dot2_f32_bf16 v35, v59, v180, v35
    v_dot2_f32_bf16 v36, v60, v180, v36
    v_dot2_f32_bf16 v37, v61, v180, v37
    v_dot2_f32_bf16 v38, v62, v180, v38
    v_dot2_f32_bf16 v39, v63, v180, v39
    v_and_b32 v13, 31, v0
    v_lshlrev_b32 v13, 2, v13
    v_add_u32 v139, 128, v13
    global_load_dword v138, v139, s[40:41] sc1
    s_waitcnt vmcnt(4)
    buffer_load_dwordx4 v[80:83], v1, s[48:51], s90 offen offset:0 nt
    s_waitcnt vmcnt(4)
    buffer_load_dwordx4 v[84:87], v1, s[48:51], s90 offen offset:1024 nt
    v_perm_b32 v56, v236, v232, s84
    v_perm_b32 v57, v236, v232, s85
    v_perm_b32 v58, v237, v233, s84
    v_perm_b32 v59, v237, v233, s85
    v_perm_b32 v60, v238, v234, s84
    v_perm_b32 v61, v238, v234, s85
    v_perm_b32 v62, v239, v235, s84
    v_perm_b32 v63, v239, v235, s85
    s_waitcnt lgkmcnt(11)
    v_dot2_f32_bf16 v32, v56, v181, v32
    v_dot2_f32_bf16 v33, v57, v181, v33
    v_dot2_f32_bf16 v34, v58, v181, v34
    v_dot2_f32_bf16 v35, v59, v181, v35
    v_dot2_f32_bf16 v36, v60, v181, v36
    v_dot2_f32_bf16 v37, v61, v181, v37
    v_dot2_f32_bf16 v38, v62, v181, v38
    v_dot2_f32_bf16 v39, v63, v181, v39
    s_waitcnt vmcnt(4)
    buffer_load_dwordx4 v[88:91], v1, s[48:51], s90 offen offset:2048 nt
    s_waitcnt vmcnt(4)
    buffer_load_dwordx4 v[92:95], v1, s[48:51], s90 offen offset:3072 nt
    v_perm_b32 v56, v244, v240, s84
    v_perm_b32 v57, v244, v240, s85
    v_perm_b32 v58, v245, v241, s84
    v_perm_b32 v59, v245, v241, s85
    v_perm_b32 v60, v246, v242, s84
    v_perm_b32 v61, v246, v242, s85
    v_perm_b32 v62, v247, v243, s84
    v_perm_b32 v63, v247, v243, s85
    s_waitcnt lgkmcnt(10)
    v_dot2_f32_bf16 v32, v56, v182, v32
    v_dot2_f32_bf16 v33, v57, v182, v33
    v_dot2_f32_bf16 v34, v58, v182, v34
    v_dot2_f32_bf16 v35, v59, v182, v35
    v_dot2_f32_bf16 v36, v60, v182, v36
    v_dot2_f32_bf16 v37, v61, v182, v37
    v_dot2_f32_bf16 v38, v62, v182, v38
    v_dot2_f32_bf16 v39, v63, v182, v39
    s_waitcnt vmcnt(4)
    buffer_load_dwordx4 v[96:99], v1, s[48:51], s91 offen offset:0 nt
    s_waitcnt vmcnt(4)
    buffer_load_dwordx4 v[100:103], v1, s[48:51], s91 offen offset:1024 nt
    v_perm_b32 v56, v252, v248, s84
    v_perm_b32 v57, v252, v248, s85
    v_perm_b32 v58, v253, v249, s84
    v_perm_b32 v59, v253, v249, s85
    v_perm_b32 v60, v254, v250, s84
    v_perm_b32 v61, v254, v250, s85
    v_perm_b32 v62, v255, v251, s84
    v_perm_b32 v63, v255, v251, s85
    s_waitcnt lgkmcnt(9)
    v_dot2_f32_bf16 v32, v56, v183, v32
    v_dot2_f32_bf16 v33, v57, v183, v33
    v_dot2_f32_bf16 v34, v58, v183, v34
    v_dot2_f32_bf16 v35, v59, v183, v35
    v_dot2_f32_bf16 v36, v60, v183, v36
    v_dot2_f32_bf16 v37, v61, v183, v37
    v_dot2_f32_bf16 v38, v62, v183, v38
    v_dot2_f32_bf16 v39, v63, v183, v39
    s_waitcnt vmcnt(4)
    buffer_load_dwordx4 v[104:107], v1, s[48:51], s91 offen offset:2048 nt
    s_waitcnt vmcnt(4)
    buffer_load_dwordx4 v[108:111], v1, s[48:51], s91 offen offset:3072 nt
    v_perm_b32 v56, v68, v64, s84
    v_perm_b32 v57, v68, v64, s85
    v_perm_b32 v58, v69, v65, s84
    v_perm_b32 v59, v69, v65, s85
    v_perm_b32 v60, v70, v66, s84
    v_perm_b32 v61, v70, v66, s85
    v_perm_b32 v62, v71, v67, s84
    v_perm_b32 v63, v71, v67, s85
    s_waitcnt lgkmcnt(8)
    v_dot2_f32_bf16 v32, v56, v184, v32
    v_dot2_f32_bf16 v33, v57, v184, v33
    v_dot2_f32_bf16 v34, v58, v184, v34
    v_dot2_f32_bf16 v35, v59, v184, v35
    v_dot2_f32_bf16 v36, v60, v184, v36
    v_dot2_f32_bf16 v37, v61, v184, v37
    v_dot2_f32_bf16 v38, v62, v184, v38
    v_dot2_f32_bf16 v39, v63, v184, v39
    s_waitcnt vmcnt(4)
    buffer_load_dwordx4 v[112:115], v1, s[48:51], s92 offen offset:0 nt
    s_waitcnt vmcnt(4)
    buffer_load_dwordx4 v[116:119], v1, s[48:51], s92 offen offset:1024 nt
    v_perm_b32 v56, v76, v72, s84
    v_perm_b32 v57, v76, v72, s85
    v_perm_b32 v58, v77, v73, s84
    v_perm_b32 v59, v77, v73, s85
    v_perm_b32 v60, v78, v74, s84
    v_perm_b32 v61, v78, v74, s85
    v_perm_b32 v62, v79, v75, s84
    v_perm_b32 v63, v79, v75, s85
    s_waitcnt lgkmcnt(7)
    v_dot2_f32_bf16 v32, v56, v185, v32
    v_dot2_f32_bf16 v33, v57, v185, v33
    v_dot2_f32_bf16 v34, v58, v185, v34
    v_dot2_f32_bf16 v35, v59, v185, v35
    v_dot2_f32_bf16 v36, v60, v185, v36
    v_dot2_f32_bf16 v37, v61, v185, v37
    v_dot2_f32_bf16 v38, v62, v185, v38
    v_dot2_f32_bf16 v39, v63, v185, v39
    s_waitcnt vmcnt(4)
    buffer_load_dwordx4 v[120:123], v1, s[48:51], s92 offen offset:2048 nt
    s_waitcnt vmcnt(4)
    buffer_load_dwordx4 v[124:127], v1, s[48:51], s92 offen offset:3072 nt
    v_perm_b32 v56, v84, v80, s84
    v_perm_b32 v57, v84, v80, s85
    v_perm_b32 v58, v85, v81, s84
    v_perm_b32 v59, v85, v81, s85
    v_perm_b32 v60, v86, v82, s84
    v_perm_b32 v61, v86, v82, s85
    v_perm_b32 v62, v87, v83, s84
    v_perm_b32 v63, v87, v83, s85
    s_waitcnt lgkmcnt(6)
    v_dot2_f32_bf16 v32, v56, v186, v32
    v_dot2_f32_bf16 v33, v57, v186, v33
    v_dot2_f32_bf16 v34, v58, v186, v34
    v_dot2_f32_bf16 v35, v59, v186, v35
    v_dot2_f32_bf16 v36, v60, v186, v36
    v_dot2_f32_bf16 v37, v61, v186, v37
    v_dot2_f32_bf16 v38, v62, v186, v38
    v_dot2_f32_bf16 v39, v63, v186, v39
    v_perm_b32 v56, v92, v88, s84
    v_perm_b32 v57, v92, v88, s85
    v_perm_b32 v58, v93, v89, s84
    v_perm_b32 v59, v93, v89, s85
    v_perm_b32 v60, v94, v90, s84
    v_perm_b32 v61, v94, v90, s85
    v_perm_b32 v62, v95, v91, s84
    v_perm_b32 v63, v95, v91, s85
    s_waitcnt lgkmcnt(5)
    v_dot2_f32_bf16 v32, v56, v187, v32
    v_dot2_f32_bf16 v33, v57, v187, v33
    v_dot2_f32_bf16 v34, v58, v187, v34
    v_dot2_f32_bf16 v35, v59, v187, v35
    v_dot2_f32_bf16 v36, v60, v187, v36
    v_dot2_f32_bf16 v37, v61, v187, v37
    v_dot2_f32_bf16 v38, v62, v187, v38
    v_dot2_f32_bf16 v39, v63, v187, v39
    v_perm_b32 v56, v100, v96, s84
    v_perm_b32 v57, v100, v96, s85
    v_perm_b32 v58, v101, v97, s84
    v_perm_b32 v59, v101, v97, s85
    v_perm_b32 v60, v102, v98, s84
    v_perm_b32 v61, v102, v98, s85
    v_perm_b32 v62, v103, v99, s84
    v_perm_b32 v63, v103, v99, s85
    s_waitcnt lgkmcnt(4)
    v_dot2_f32_bf16 v32, v56, v188, v32
    v_dot2_f32_bf16 v33, v57, v188, v33
    v_dot2_f32_bf16 v34, v58, v188, v34
    v_dot2_f32_bf16 v35, v59, v188, v35
    v_dot2_f32_bf16 v36, v60, v188, v36
    v_dot2_f32_bf16 v37, v61, v188, v37
    v_dot2_f32_bf16 v38, v62, v188, v38
    v_dot2_f32_bf16 v39, v63, v188, v39
    s_waitcnt vmcnt(4)
    v_perm_b32 v56, v108, v104, s84
    v_perm_b32 v57, v108, v104, s85
    v_perm_b32 v58, v109, v105, s84
    v_perm_b32 v59, v109, v105, s85
    v_perm_b32 v60, v110, v106, s84
    v_perm_b32 v61, v110, v106, s85
    v_perm_b32 v62, v111, v107, s84
    v_perm_b32 v63, v111, v107, s85
    s_waitcnt lgkmcnt(3)
    v_dot2_f32_bf16 v32, v56, v189, v32
    v_dot2_f32_bf16 v33, v57, v189, v33
    v_dot2_f32_bf16 v34, v58, v189, v34
    v_dot2_f32_bf16 v35, v59, v189, v35
    v_dot2_f32_bf16 v36, v60, v189, v36
    v_dot2_f32_bf16 v37, v61, v189, v37
    v_dot2_f32_bf16 v38, v62, v189, v38
    v_dot2_f32_bf16 v39, v63, v189, v39
    s_waitcnt vmcnt(2)
    v_perm_b32 v56, v116, v112, s84
    v_perm_b32 v57, v116, v112, s85
    v_perm_b32 v58, v117, v113, s84
    v_perm_b32 v59, v117, v113, s85
    v_perm_b32 v60, v118, v114, s84
    v_perm_b32 v61, v118, v114, s85
    v_perm_b32 v62, v119, v115, s84
    v_perm_b32 v63, v119, v115, s85
    s_waitcnt lgkmcnt(2)
    v_dot2_f32_bf16 v32, v56, v190, v32
    v_dot2_f32_bf16 v33, v57, v190, v33
    v_dot2_f32_bf16 v34, v58, v190, v34
    v_dot2_f32_bf16 v35, v59, v190, v35
    v_dot2_f32_bf16 v36, v60, v190, v36
    v_dot2_f32_bf16 v37, v61, v190, v37
    v_dot2_f32_bf16 v38, v62, v190, v38
    v_dot2_f32_bf16 v39, v63, v190, v39
    s_waitcnt vmcnt(0)
    v_perm_b32 v56, v124, v120, s84
    v_perm_b32 v57, v124, v120, s85
    v_perm_b32 v58, v125, v121, s84
    v_perm_b32 v59, v125, v121, s85
    v_perm_b32 v60, v126, v122, s84
    v_perm_b32 v61, v126, v122, s85
    v_perm_b32 v62, v127, v123, s84
    v_perm_b32 v63, v127, v123, s85
    s_waitcnt lgkmcnt(1)
    v_dot2_f32_bf16 v32, v56, v191, v32
    v_dot2_f32_bf16 v33, v57, v191, v33
    v_dot2_f32_bf16 v34, v58, v191, v34
    v_dot2_f32_bf16 v35, v59, v191, v35
    v_dot2_f32_bf16 v36, v60, v191, v36
    v_dot2_f32_bf16 v37, v61, v191, v37
    v_dot2_f32_bf16 v38, v62, v191, v38
    v_dot2_f32_bf16 v39, v63, v191, v39
    v_permlane32_swap_b32 v32, v36
    v_permlane32_swap_b32 v33, v37
    v_permlane32_swap_b32 v34, v38
    v_permlane32_swap_b32 v35, v39
    v_add_f32 v44, v32, v36
    v_add_f32 v45, v33, v37
    v_add_f32 v46, v34, v38
    v_add_f32 v47, v35, v39
    ds_write_b128 v10, v[44:47]
    v_and_b32 v13, 7, v0
    v_lshlrev_b32 v13, 2, v13
    s_waitcnt lgkmcnt(0)
    s_barrier
    ds_read_b32 v52, v13 offset:8320
    ds_read_b32 v55, v13 offset:8352
    ds_read_b128 v[48:51], v12
    s_waitcnt lgkmcnt(2)
    v_max_f32_dpp v54, v52, v52 quad_perm:[1,0,3,2] row_mask:0xf bank_mask:0xf
    s_nop 1
    v_max_f32_dpp v54, v54, v54 quad_perm:[2,3,0,1] row_mask:0xf bank_mask:0xf
    s_nop 1
    v_max_f32_dpp v54, v54, v54 row_half_mirror row_mask:0xf bank_mask:0xf
    v_sub_f32 v53, v52, v54
    v_mul_f32 v53, 0x3db8aa3b, v53
    v_exp_f32 v53, v53
    s_waitcnt lgkmcnt(1)
    v_mul_f32 v55, v55, v53
    s_waitcnt lgkmcnt(0)
    v_mul_f32 v48, v48, v53
    v_mul_f32 v49, v49, v53
    v_mul_f32 v50, v50, v53
    v_mul_f32 v51, v51, v53
    v_add_f32_dpp v55, v55, v55 quad_perm:[1,0,3,2] row_mask:0xf bank_mask:0xf
    v_add_f32_dpp v48, v48, v48 quad_perm:[1,0,3,2] row_mask:0xf bank_mask:0xf
    v_add_f32_dpp v49, v49, v49 quad_perm:[1,0,3,2] row_mask:0xf bank_mask:0xf
    v_add_f32_dpp v50, v50, v50 quad_perm:[1,0,3,2] row_mask:0xf bank_mask:0xf
    v_add_f32_dpp v51, v51, v51 quad_perm:[1,0,3,2] row_mask:0xf bank_mask:0xf
    v_add_f32_dpp v55, v55, v55 quad_perm:[2,3,0,1] row_mask:0xf bank_mask:0xf
    v_add_f32_dpp v48, v48, v48 quad_perm:[2,3,0,1] row_mask:0xf bank_mask:0xf
    v_add_f32_dpp v49, v49, v49 quad_perm:[2,3,0,1] row_mask:0xf bank_mask:0xf
    v_add_f32_dpp v50, v50, v50 quad_perm:[2,3,0,1] row_mask:0xf bank_mask:0xf
    v_add_f32_dpp v51, v51, v51 quad_perm:[2,3,0,1] row_mask:0xf bank_mask:0xf
    v_add_f32_dpp v55, v55, v55 row_half_mirror row_mask:0xf bank_mask:0xf
    v_add_f32_dpp v48, v48, v48 row_half_mirror row_mask:0xf bank_mask:0xf
    v_add_f32_dpp v49, v49, v49 row_half_mirror row_mask:0xf bank_mask:0xf
    v_add_f32_dpp v50, v50, v50 row_half_mirror row_mask:0xf bank_mask:0xf
    v_add_f32_dpp v51, v51, v51 row_half_mirror row_mask:0xf bank_mask:0xf
    s_mov_b32 exec_lo, 0x01010101
    s_mov_b32 exec_hi, 0x01010101
    global_store_dwordx4 v3, v[48:51], s[42:43] sc1
    s_mov_b64 exec, 1
    global_store_dwordx2 v4, v[54:55], s[42:43] sc1
    s_mov_b64 exec, -1
    s_mov_b32 s100, 20000
L_POLL1:
    global_load_dwordx4 v[64:67], v6, s[42:43] sc1
    global_load_dwordx4 v[68:71], v6, s[42:43] offset:1024 sc1
    global_load_dwordx2 v[72:73], v7, s[42:43] sc1
    global_load_dwordx2 v[74:75], v7, s[42:43] offset:64 sc1
    s_sub_u32 s100, s100, 1
    s_cmp_eq_u32 s100, 0
    s_waitcnt vmcnt(0)
    s_cbranch_scc1 L_POLL1_DONE
    v_max3_u32 v76, v64, v65, v66
    v_max3_u32 v77, v67, v68, v69
    v_max3_u32 v76, v76, v70, v71
    v_max3_u32 v77, v77, v72, v73
    v_max3_u32 v76, v76, v74, v75
    v_max_u32 v76, v76, v77
    v_cmp_eq_u32 vcc, -1, v76
    s_cbranch_vccnz L_POLL1
L_POLL1_DONE:
    s_nop 0
    v_max_f32_dpp v76, v72, v72 quad_perm:[1,0,3,2] row_mask:0xf bank_mask:0xf
    v_max_f32_dpp v77, v74, v74 quad_perm:[1,0,3,2] row_mask:0xf bank_mask:0xf
    s_nop 0
    v_max_f32_dpp v76, v76, v76 quad_perm:[2,3,0,1] row_mask:0xf bank_mask:0xf
    v_max_f32_dpp v77, v77, v77 quad_perm:[2,3,0,1] row_mask:0xf bank_mask:0xf
    s_nop 0
    v_max_f32_dpp v76, v76, v76 row_half_mirror row_mask:0xf bank_mask:0xf
    v_max_f32_dpp v77, v77, v77 row_half_mirror row_mask:0xf bank_mask:0xf
    v_sub_f32 v78, v72, v76
    v_sub_f32 v79, v74, v77
    v_mul_f32 v78, 0x3db8aa3b, v78
    v_mul_f32 v79, 0x3db8aa3b, v79
    v_exp_f32 v78, v78
    v_exp_f32 v79, v79
    v_mul_f32 v80, v73, v78
    v_mul_f32 v81, v75, v79
    v_pk_mul_f32 v[64:65], v[64:65], v[78:79] op_sel:[0,0] op_sel_hi:[1,0]
    v_pk_mul_f32 v[66:67], v[66:67], v[78:79] op_sel:[0,0] op_sel_hi:[1,0]
    v_pk_mul_f32 v[68:69], v[68:69], v[78:79] op_sel:[0,1] op_sel_hi:[1,1]
    v_pk_mul_f32 v[70:71], v[70:71], v[78:79] op_sel:[0,1] op_sel_hi:[1,1]
    v_add_f32_dpp v80, v80, v80 quad_perm:[1,0,3,2] row_mask:0xf bank_mask:0xf
    v_add_f32_dpp v81, v81, v81 quad_perm:[1,0,3,2] row_mask:0xf bank_mask:0xf
    v_add_f32_dpp v64, v64, v64 quad_perm:[1,0,3,2] row_mask:0xf bank_mask:0xf
    v_add_f32_dpp v65, v65, v65 quad_perm:[1,0,3,2] row_mask:0xf bank_mask:0xf
    v_add_f32_dpp v66, v66, v66 quad_perm:[1,0,3,2] row_mask:0xf bank_mask:0xf
    v_add_f32_dpp v67, v67, v67 quad_perm:[1,0,3,2] row_mask:0xf bank_mask:0xf
    v_add_f32_dpp v68, v68, v68 quad_perm:[1,0,3,2] row_mask:0xf bank_mask:0xf
    v_add_f32_dpp v69, v69, v69 quad_perm:[1,0,3,2] row_mask:0xf bank_mask:0xf
    v_add_f32_dpp v70, v70, v70 quad_perm:[1,0,3,2] row_mask:0xf bank_mask:0xf
    v_add_f32_dpp v71, v71, v71 quad_perm:[1,0,3,2] row_mask:0xf bank_mask:0xf
    v_add_f32_dpp v80, v80, v80 quad_perm:[2,3,0,1] row_mask:0xf bank_mask:0xf
    v_add_f32_dpp v81, v81, v81 quad_perm:[2,3,0,1] row_mask:0xf bank_mask:0xf
    v_add_f32_dpp v64, v64, v64 quad_perm:[2,3,0,1] row_mask:0xf bank_mask:0xf
    v_add_f32_dpp v65, v65, v65 quad_perm:[2,3,0,1] row_mask:0xf bank_mask:0xf
    v_add_f32_dpp v66, v66, v66 quad_perm:[2,3,0,1] row_mask:0xf bank_mask:0xf
    v_add_f32_dpp v67, v67, v67 quad_perm:[2,3,0,1] row_mask:0xf bank_mask:0xf
    v_add_f32_dpp v68, v68, v68 quad_perm:[2,3,0,1] row_mask:0xf bank_mask:0xf
    v_add_f32_dpp v69, v69, v69 quad_perm:[2,3,0,1] row_mask:0xf bank_mask:0xf
    v_add_f32_dpp v70, v70, v70 quad_perm:[2,3,0,1] row_mask:0xf bank_mask:0xf
    v_add_f32_dpp v71, v71, v71 quad_perm:[2,3,0,1] row_mask:0xf bank_mask:0xf
    v_add_f32_dpp v80, v80, v80 row_half_mirror row_mask:0xf bank_mask:0xf
    v_add_f32_dpp v81, v81, v81 row_half_mirror row_mask:0xf bank_mask:0xf
    v_add_f32_dpp v64, v64, v64 row_half_mirror row_mask:0xf bank_mask:0xf
    v_add_f32_dpp v65, v65, v65 row_half_mirror row_mask:0xf bank_mask:0xf
    v_add_f32_dpp v66, v66, v66 row_half_mirror row_mask:0xf bank_mask:0xf
    v_add_f32_dpp v67, v67, v67 row_half_mirror row_mask:0xf bank_mask:0xf
    v_add_f32_dpp v68, v68, v68 row_half_mirror row_mask:0xf bank_mask:0xf
    v_add_f32_dpp v69, v69, v69 row_half_mirror row_mask:0xf bank_mask:0xf
    v_add_f32_dpp v70, v70, v70 row_half_mirror row_mask:0xf bank_mask:0xf
    v_add_f32_dpp v71, v71, v71 row_half_mirror row_mask:0xf bank_mask:0xf
    v_rcp_f32 v80, v80
    v_rcp_f32 v81, v81
    v_lshrrev_b32 v13, 3, v0
    v_lshlrev_b32 v13, 4, v13
    v_pk_mul_f32 v[64:65], v[64:65], v[80:81] op_sel:[0,0] op_sel_hi:[1,0]
    v_pk_mul_f32 v[66:67], v[66:67], v[80:81] op_sel:[0,0] op_sel_hi:[1,0]
    v_pk_mul_f32 v[68:69], v[68:69], v[80:81] op_sel:[0,1] op_sel_hi:[1,1]
    v_pk_mul_f32 v[70:71], v[70:71], v[80:81] op_sel:[0,1] op_sel_hi:[1,1]
    v_cvt_pk_bf16_f32 v72, v64, v65
    v_cvt_pk_bf16_f32 v73, v66, v67
    v_cvt_pk_bf16_f32 v74, v68, v69
    v_cvt_pk_bf16_f32 v75, v70, v71
    s_mov_b32 exec_lo, 0x01010101
    s_mov_b32 exec_hi, 0x01010101
    ds_write_b128 v13, v[72:75] offset:8384
    s_mov_b64 exec, -1
    s_waitcnt lgkmcnt(0)
    s_barrier
    s_cmp_ge_u32 s8, 56
    s_cbranch_scc1 L_FIN
    v_cmp_ne_u32 vcc, 8, v138
    s_cbranch_vccnz L_CHK_SLOW
L_CHK_OK:
    s_mul_i32 s94, s13, 896
    s_lshl_b32 s95, s12, 5
    s_add_u32 s94, s94, s95
    v_lshrrev_b32 v13, 4, v0
    v_lshl_add_u32 v13, v13, 3, s94
    s_mov_b32 s100, 20000
L_POLLF:
    global_load_dwordx4 v[64:67], v143, s[42:43] offset:0 sc1
    global_load_dwordx4 v[68:71], v143, s[42:43] offset:1024 sc1
    global_load_dwordx4 v[72:75], v143, s[42:43] offset:2048 sc1
    global_load_dwordx4 v[76:79], v143, s[42:43] offset:3072 sc1
    global_load_dwordx4 v[80:83], v144, s[42:43] offset:0 sc1
    global_load_dwordx4 v[84:87], v144, s[42:43] offset:1024 sc1
    global_load_dwordx4 v[88:91], v144, s[42:43] offset:2048 sc1
    global_load_dwordx4 v[92:95], v144, s[42:43] offset:3072 sc1
    global_load_dwordx4 v[96:99], v8, s[42:43] offset:0 sc1
    global_load_dwordx4 v[100:103], v8, s[42:43] offset:1024 sc1
    global_load_dwordx4 v[104:107], v8, s[42:43] offset:2048 sc1
    global_load_dwordx4 v[108:111], v8, s[42:43] offset:3072 sc1
    global_load_dwordx4 v[112:115], v142, s[42:43] offset:0 sc1
    global_load_dwordx4 v[116:119], v142, s[42:43] offset:1024 sc1
    global_load_dwordx4 v[120:123], v142, s[42:43] offset:2048 sc1
    global_load_dwordx4 v[124:127], v142, s[42:43] offset:3072 sc1
    s_sub_u32 s100, s100, 1
    s_cmp_eq_u32 s100, 0
    s_waitcnt vmcnt(8)
    s_cbranch_scc1 L_POLLF_DONE
    v_max3_u32 v48, v64, v65, v66
    v_max3_u32 v49, v67, v68, v69
    v_max3_u32 v48, v48, v70, v71
    v_max3_u32 v49, v49, v72, v73
    v_max3_u32 v48, v48, v74, v75
    v_max3_u32 v49, v49, v76, v77
    v_max3_u32 v48, v48, v78, v79
    v_max3_u32 v49, v49, v80, v81
    v_max3_u32 v48, v48, v82, v83
    v_max3_u32 v49, v49, v84, v85
    v_max3_u32 v48, v48, v86, v87
    v_max3_u32 v49, v49, v88, v89
    v_max3_u32 v48, v48, v90, v91
    v_max3_u32 v49, v49, v92, v93
    v_max3_u32 v48, v48, v94, v95
    v_max_u32 v48, v48, v49
    v_cmp_eq_u32 vcc, -1, v48
    s_waitcnt vmcnt(0)
    s_cbranch_vccnz L_POLLF
L_POLLF_DONE:
    s_waitcnt vmcnt(0)
    v_max3_u32 v48, v96, v97, v98
    v_max3_u32 v49, v99, v100, v101
    v_max3_u32 v48, v48, v102, v103
    v_max3_u32 v49, v49, v104, v105
    v_max3_u32 v48, v48, v106, v107
    v_max3_u32 v49, v49, v108, v109
    v_max3_u32 v48, v48, v110, v111
    v_max3_u32 v49, v49, v112, v113
    v_max3_u32 v48, v48, v114, v115
    v_max3_u32 v49, v49, v116, v117
    v_max3_u32 v48, v48, v118, v119
    v_max3_u32 v49, v49, v120, v121
    v_max3_u32 v48, v48, v122, v123
    v_max3_u32 v49, v49, v124, v125
    v_max3_u32 v48, v48, v126, v127
    v_max_u32 v48, v48, v49
    v_cmp_eq_u32 vcc, -1, v48
    s_cbranch_vccnz L_POLLY0
    v_pk_add_f32 v[64:65], v[64:65], v[80:81]
    v_pk_add_f32 v[66:67], v[66:67], v[82:83]
    v_pk_add_f32 v[68:69], v[68:69], v[84:85]
    v_pk_add_f32 v[70:71], v[70:71], v[86:87]
    v_pk_add_f32 v[72:73], v[72:73], v[88:89]
    v_pk_add_f32 v[74:75], v[74:75], v[90:91]
    v_pk_add_f32 v[76:77], v[76:77], v[92:93]
    v_pk_add_f32 v[78:79], v[78:79], v[94:95]
    v_pk_add_f32 v[64:65], v[64:65], v[72:73]
    v_pk_add_f32 v[66:67], v[66:67], v[74:75]
    v_pk_add_f32 v[68:69], v[68:69], v[76:77]
    v_pk_add_f32 v[70:71], v[70:71], v[78:79]
    v_pk_add_f32 v[64:65], v[64:65], v[68:69]
    v_pk_add_f32 v[66:67], v[66:67], v[70:71]
    s_nop 0
    v_add_f32_dpp v64, v64, v64 row_ror:8 row_mask:0xf bank_mask:0xf
    v_add_f32_dpp v65, v65, v65 row_ror:8 row_mask:0xf bank_mask:0xf
    v_add_f32_dpp v66, v66, v66 row_ror:8 row_mask:0xf bank_mask:0xf
    v_add_f32_dpp v67, v67, v67 row_ror:8 row_mask:0xf bank_mask:0xf
    v_add_f32_dpp v64, v64, v64 row_ror:4 row_mask:0xf bank_mask:0xf
    v_add_f32_dpp v65, v65, v65 row_ror:4 row_mask:0xf bank_mask:0xf
    v_add_f32_dpp v66, v66, v66 row_ror:4 row_mask:0xf bank_mask:0xf
    v_add_f32_dpp v67, v67, v67 row_ror:4 row_mask:0xf bank_mask:0xf
    v_add_f32_dpp v64, v64, v64 row_ror:2 row_mask:0xf bank_mask:0xf
    v_add_f32_dpp v65, v65, v65 row_ror:2 row_mask:0xf bank_mask:0xf
    v_add_f32_dpp v66, v66, v66 row_ror:2 row_mask:0xf bank_mask:0xf
    v_add_f32_dpp v67, v67, v67 row_ror:2 row_mask:0xf bank_mask:0xf
    v_add_f32_dpp v64, v64, v64 row_ror:1 row_mask:0xf bank_mask:0xf
    v_add_f32_dpp v65, v65, v65 row_ror:1 row_mask:0xf bank_mask:0xf
    v_add_f32_dpp v66, v66, v66 row_ror:1 row_mask:0xf bank_mask:0xf
    v_add_f32_dpp v67, v67, v67 row_ror:1 row_mask:0xf bank_mask:0xf
    v_cvt_pk_bf16_f32 v68, v64, v65
    v_cvt_pk_bf16_f32 v69, v66, v67
    v_lshlrev_b32 v64, 16, v68
    v_and_b32 v65, 0xffff0000, v68
    v_lshlrev_b32 v66, 16, v69
    v_and_b32 v67, 0xffff0000, v69
    v_add_f32 v64, v64, v24
    v_add_f32 v65, v65, v25
    v_add_f32 v66, v66, v26
    v_add_f32 v67, v67, v27
    v_cvt_pk_bf16_f32 v68, v64, v65
    v_cvt_pk_bf16_f32 v69, v66, v67
    v_lshlrev_b32 v64, 16, v68
    v_and_b32 v65, 0xffff0000, v68
    v_lshlrev_b32 v66, 16, v69
    v_and_b32 v67, 0xffff0000, v69
    v_mul_f32 v64, v64, v141
    v_mul_f32 v65, v65, v141
    v_mul_f32 v66, v66, v141
    v_mul_f32 v67, v67, v141
    v_cvt_pk_bf16_f32 v68, v64, v65
    v_cvt_pk_bf16_f32 v69, v66, v67
    v_lshlrev_b32 v64, 16, v68
    v_and_b32 v65, 0xffff0000, v68
    v_lshlrev_b32 v66, 16, v69
    v_and_b32 v67, 0xffff0000, v69
    s_branch L_POLLY_DONE
L_POLLY0:
    global_load_dwordx4 v[96:99], v8, s[42:43] offset:0 sc1
    global_load_dwordx4 v[100:103], v8, s[42:43] offset:1024 sc1
    global_load_dwordx4 v[104:107], v8, s[42:43] offset:2048 sc1
    global_load_dwordx4 v[108:111], v8, s[42:43] offset:3072 sc1
    global_load_dwordx4 v[112:115], v142, s[42:43] offset:0 sc1
    global_load_dwordx4 v[116:119], v142, s[42:43] offset:1024 sc1
    global_load_dwordx4 v[120:123], v142, s[42:43] offset:2048 sc1
    global_load_dwordx4 v[124:127], v142, s[42:43] offset:3072 sc1
    v_pk_add_f32 v[64:65], v[64:65], v[80:81]
    v_pk_add_f32 v[66:67], v[66:67], v[82:83]
    v_pk_add_f32 v[68:69], v[68:69], v[84:85]
    v_pk_add_f32 v[70:71], v[70:71], v[86:87]
    v_pk_add_f32 v[72:73], v[72:73], v[88:89]
    v_pk_add_f32 v[74:75], v[74:75], v[90:91]
    v_pk_add_f32 v[76:77], v[76:77], v[92:93]
    v_pk_add_f32 v[78:79], v[78:79], v[94:95]
    v_pk_add_f32 v[64:65], v[64:65], v[72:73]
    v_pk_add_f32 v[66:67], v[66:67], v[74:75]
    v_pk_add_f32 v[68:69], v[68:69], v[76:77]
    v_pk_add_f32 v[70:71], v[70:71], v[78:79]
    v_pk_add_f32 v[64:65], v[64:65], v[68:69]
    v_pk_add_f32 v[66:67], v[66:67], v[70:71]
    s_nop 0
    v_add_f32_dpp v64, v64, v64 row_ror:8 row_mask:0xf bank_mask:0xf
    v_add_f32_dpp v65, v65, v65 row_ror:8 row_mask:0xf bank_mask:0xf
    v_add_f32_dpp v66, v66, v66 row_ror:8 row_mask:0xf bank_mask:0xf
    v_add_f32_dpp v67, v67, v67 row_ror:8 row_mask:0xf bank_mask:0xf
    v_add_f32_dpp v64, v64, v64 row_ror:4 row_mask:0xf bank_mask:0xf
    v_add_f32_dpp v65, v65, v65 row_ror:4 row_mask:0xf bank_mask:0xf
    v_add_f32_dpp v66, v66, v66 row_ror:4 row_mask:0xf bank_mask:0xf
    v_add_f32_dpp v67, v67, v67 row_ror:4 row_mask:0xf bank_mask:0xf
    v_add_f32_dpp v64, v64, v64 row_ror:2 row_mask:0xf bank_mask:0xf
    v_add_f32_dpp v65, v65, v65 row_ror:2 row_mask:0xf bank_mask:0xf
    v_add_f32_dpp v66, v66, v66 row_ror:2 row_mask:0xf bank_mask:0xf
    v_add_f32_dpp v67, v67, v67 row_ror:2 row_mask:0xf bank_mask:0xf
    v_add_f32_dpp v64, v64, v64 row_ror:1 row_mask:0xf bank_mask:0xf
    v_add_f32_dpp v65, v65, v65 row_ror:1 row_mask:0xf bank_mask:0xf
    v_add_f32_dpp v66, v66, v66 row_ror:1 row_mask:0xf bank_mask:0xf
    v_add_f32_dpp v67, v67, v67 row_ror:1 row_mask:0xf bank_mask:0xf
    v_cvt_pk_bf16_f32 v68, v64, v65
    v_cvt_pk_bf16_f32 v69, v66, v67
    v_lshlrev_b32 v64, 16, v68
    v_and_b32 v65, 0xffff0000, v68
    v_lshlrev_b32 v66, 16, v69
    v_and_b32 v67, 0xffff0000, v69
    v_add_f32 v64, v64, v24
    v_add_f32 v65, v65, v25
    v_add_f32 v66, v66, v26
    v_add_f32 v67, v67, v27
    v_cvt_pk_bf16_f32 v68, v64, v65
    v_cvt_pk_bf16_f32 v69, v66, v67
    v_lshlrev_b32 v64, 16, v68
    v_and_b32 v65, 0xffff0000, v68
    v_lshlrev_b32 v66, 16, v69
    v_and_b32 v67, 0xffff0000, v69
    v_mul_f32 v64, v64, v141
    v_mul_f32 v65, v65, v141
    v_mul_f32 v66, v66, v141
    v_mul_f32 v67, v67, v141
    v_cvt_pk_bf16_f32 v68, v64, v65
    v_cvt_pk_bf16_f32 v69, v66, v67
    v_lshlrev_b32 v64, 16, v68
    v_and_b32 v65, 0xffff0000, v68
    v_lshlrev_b32 v66, 16, v69
    v_and_b32 v67, 0xffff0000, v69
    global_load_dwordx4 v[160:163], v8, s[42:43] offset:0 sc1
    global_load_dwordx4 v[164:167], v8, s[42:43] offset:1024 sc1
    global_load_dwordx4 v[168:171], v8, s[42:43] offset:2048 sc1
    global_load_dwordx4 v[172:175], v8, s[42:43] offset:3072 sc1
    global_load_dwordx4 v[176:179], v142, s[42:43] offset:0 sc1
    global_load_dwordx4 v[180:183], v142, s[42:43] offset:1024 sc1
    global_load_dwordx4 v[184:187], v142, s[42:43] offset:2048 sc1
    global_load_dwordx4 v[188:191], v142, s[42:43] offset:3072 sc1
    s_mov_b32 s100, 20000
L_POLLY:
    s_waitcnt vmcnt(8)
    v_max3_u32 v48, v96, v97, v98
    v_max3_u32 v49, v99, v100, v101
    v_max3_u32 v48, v48, v102, v103
    v_max3_u32 v49, v49, v104, v105
    v_max3_u32 v48, v48, v106, v107
    v_max3_u32 v49, v49, v108, v109
    v_max3_u32 v48, v48, v110, v111
    v_max3_u32 v49, v49, v112, v113
    v_max3_u32 v48, v48, v114, v115
    v_max3_u32 v49, v49, v116, v117
    v_max3_u32 v48, v48, v118, v119
    v_max3_u32 v49, v49, v120, v121
    v_max3_u32 v48, v48, v122, v123
    v_max3_u32 v49, v49, v124, v125
    v_max3_u32 v48, v48, v126, v127
    v_max_u32 v48, v48, v49
    v_cmp_eq_u32 vcc, -1, v48
    s_sub_u32 s100, s100, 1
    s_cbranch_vccz L_POLLY_DONE
    s_cmp_eq_u32 s100, 0
    s_cbranch_scc1 L_POLLY_DONE
    global_load_dwordx4 v[96:99], v8, s[42:43] offset:0 sc1
    global_load_dwordx4 v[100:103], v8, s[42:43] offset:1024 sc1
    global_load_dwordx4 v[104:107], v8, s[42:43] offset:2048 sc1
    global_load_dwordx4 v[108:111], v8, s[42:43] offset:3072 sc1
    global_load_dwordx4 v[112:115], v142, s[42:43] offset:0 sc1
    global_load_dwordx4 v[116:119], v142, s[42:43] offset:1024 sc1
    global_load_dwordx4 v[120:123], v142, s[42:43] offset:2048 sc1
    global_load_dwordx4 v[124:127], v142, s[42:43] offset:3072 sc1
    s_waitcnt vmcnt(8)
    v_max3_u32 v48, v160, v161, v162
    v_max3_u32 v49, v163, v164, v165
    v_max3_u32 v48, v48, v166, v167
    v_max3_u32 v49, v49, v168, v169
    v_max3_u32 v48, v48, v170, v171
    v_max3_u32 v49, v49, v172, v173
    v_max3_u32 v48, v48, v174, v175
    v_max3_u32 v49, v49, v176, v177
    v_max3_u32 v48, v48, v178, v179
    v_max3_u32 v49, v49, v180, v181
    v_max3_u32 v48, v48, v182, v183
    v_max3_u32 v49, v49, v184, v185
    v_max3_u32 v48, v48, v186, v187
    v_max3_u32 v49, v49, v188, v189
    v_max3_u32 v48, v48, v190, v191
    v_max_u32 v48, v48, v49
    v_cmp_eq_u32 vcc, -1, v48
    s_cbranch_vccz L_POLLY_DONE_B
    global_load_dwordx4 v[160:163], v8, s[42:43] offset:0 sc1
    global_load_dwordx4 v[164:167], v8, s[42:43] offset:1024 sc1
    global_load_dwordx4 v[168:171], v8, s[42:43] offset:2048 sc1
    global_load_dwordx4 v[172:175], v8, s[42:43] offset:3072 sc1
    global_load_dwordx4 v[176:179], v142, s[42:43] offset:0 sc1
    global_load_dwordx4 v[180:183], v142, s[42:43] offset:1024 sc1
    global_load_dwordx4 v[184:187], v142, s[42:43] offset:2048 sc1
    global_load_dwordx4 v[188:191], v142, s[42:43] offset:3072 sc1
    s_branch L_POLLY
L_POLLY_DONE_B:
    s_nop 1
    v_pk_add_f32 v[160:161], v[160:161], v[176:177]
    v_pk_add_f32 v[162:163], v[162:163], v[178:179]
    v_pk_add_f32 v[164:165], v[164:165], v[180:181]
    v_pk_add_f32 v[166:167], v[166:167], v[182:183]
    v_pk_add_f32 v[168:169], v[168:169], v[184:185]
    v_pk_add_f32 v[170:171], v[170:171], v[186:187]
    v_pk_add_f32 v[172:173], v[172:173], v[188:189]
    v_pk_add_f32 v[174:175], v[174:175], v[190:191]
    v_pk_add_f32 v[160:161], v[160:161], v[168:169]
    v_pk_add_f32 v[162:163], v[162:163], v[170:171]
    v_pk_add_f32 v[164:165], v[164:165], v[172:173]
    v_pk_add_f32 v[166:167], v[166:167], v[174:175]
    v_pk_add_f32 v[160:161], v[160:161], v[164:165]
    v_pk_add_f32 v[162:163], v[162:163], v[166:167]
    s_nop 0
    v_add_f32_dpp v160, v160, v160 row_ror:8 row_mask:0xf bank_mask:0xf
    v_add_f32_dpp v161, v161, v161 row_ror:8 row_mask:0xf bank_mask:0xf
    v_add_f32_dpp v162, v162, v162 row_ror:8 row_mask:0xf bank_mask:0xf
    v_add_f32_dpp v163, v163, v163 row_ror:8 row_mask:0xf bank_mask:0xf
    v_add_f32_dpp v160, v160, v160 row_ror:4 row_mask:0xf bank_mask:0xf
    v_add_f32_dpp v161, v161, v161 row_ror:4 row_mask:0xf bank_mask:0xf
    v_add_f32_dpp v162, v162, v162 row_ror:4 row_mask:0xf bank_mask:0xf
    v_add_f32_dpp v163, v163, v163 row_ror:4 row_mask:0xf bank_mask:0xf
    v_add_f32_dpp v160, v160, v160 row_ror:2 row_mask:0xf bank_mask:0xf
    v_add_f32_dpp v161, v161, v161 row_ror:2 row_mask:0xf bank_mask:0xf
    v_add_f32_dpp v162, v162, v162 row_ror:2 row_mask:0xf bank_mask:0xf
    v_add_f32_dpp v163, v163, v163 row_ror:2 row_mask:0xf bank_mask:0xf
    v_add_f32_dpp v160, v160, v160 row_ror:1 row_mask:0xf bank_mask:0xf
    v_add_f32_dpp v161, v161, v161 row_ror:1 row_mask:0xf bank_mask:0xf
    v_add_f32_dpp v162, v162, v162 row_ror:1 row_mask:0xf bank_mask:0xf
    v_add_f32_dpp v163, v163, v163 row_ror:1 row_mask:0xf bank_mask:0xf
    v_fma_f32 v160, v160, v140, v64
    v_fma_f32 v161, v161, v140, v65
    v_fma_f32 v162, v162, v140, v66
    v_fma_f32 v163, v163, v140, v67
    v_cvt_pk_bf16_f32 v160, v160, v161
    v_cvt_pk_bf16_f32 v161, v162, v163
    s_mov_b32 exec_lo, 0x00010001
    s_mov_b32 exec_hi, 0x00010001
    global_store_dwordx2 v13, v[160:161], s[38:39]
    s_mov_b64 exec, -1
    s_waitcnt vmcnt(0)
    s_branch L_H2_JOIN
L_POLLY_DONE:
    s_nop 1
    v_pk_add_f32 v[96:97], v[96:97], v[112:113]
    v_pk_add_f32 v[98:99], v[98:99], v[114:115]
    v_pk_add_f32 v[100:101], v[100:101], v[116:117]
    v_pk_add_f32 v[102:103], v[102:103], v[118:119]
    v_pk_add_f32 v[104:105], v[104:105], v[120:121]
    v_pk_add_f32 v[106:107], v[106:107], v[122:123]
    v_pk_add_f32 v[108:109], v[108:109], v[124:125]
    v_pk_add_f32 v[110:111], v[110:111], v[126:127]
    v_pk_add_f32 v[96:97], v[96:97], v[104:105]
    v_pk_add_f32 v[98:99], v[98:99], v[106:107]
    v_pk_add_f32 v[100:101], v[100:101], v[108:109]
    v_pk_add_f32 v[102:103], v[102:103], v[110:111]
    v_pk_add_f32 v[96:97], v[96:97], v[100:101]
    v_pk_add_f32 v[98:99], v[98:99], v[102:103]
    s_nop 0
    v_add_f32_dpp v96, v96, v96 row_ror:8 row_mask:0xf bank_mask:0xf
    v_add_f32_dpp v97, v97, v97 row_ror:8 row_mask:0xf bank_mask:0xf
    v_add_f32_dpp v98, v98, v98 row_ror:8 row_mask:0xf bank_mask:0xf
    v_add_f32_dpp v99, v99, v99 row_ror:8 row_mask:0xf bank_mask:0xf
    v_add_f32_dpp v96, v96, v96 row_ror:4 row_mask:0xf bank_mask:0xf
    v_add_f32_dpp v97, v97, v97 row_ror:4 row_mask:0xf bank_mask:0xf
    v_add_f32_dpp v98, v98, v98 row_ror:4 row_mask:0xf bank_mask:0xf
    v_add_f32_dpp v99, v99, v99 row_ror:4 row_mask:0xf bank_mask:0xf
    v_add_f32_dpp v96, v96, v96 row_ror:2 row_mask:0xf bank_mask:0xf
    v_add_f32_dpp v97, v97, v97 row_ror:2 row_mask:0xf bank_mask:0xf
    v_add_f32_dpp v98, v98, v98 row_ror:2 row_mask:0xf bank_mask:0xf
    v_add_f32_dpp v99, v99, v99 row_ror:2 row_mask:0xf bank_mask:0xf
    v_add_f32_dpp v96, v96, v96 row_ror:1 row_mask:0xf bank_mask:0xf
    v_add_f32_dpp v97, v97, v97 row_ror:1 row_mask:0xf bank_mask:0xf
    v_add_f32_dpp v98, v98, v98 row_ror:1 row_mask:0xf bank_mask:0xf
    v_add_f32_dpp v99, v99, v99 row_ror:1 row_mask:0xf bank_mask:0xf
    v_fma_f32 v96, v96, v140, v64
    v_fma_f32 v97, v97, v140, v65
    v_fma_f32 v98, v98, v140, v66
    v_fma_f32 v99, v99, v140, v67
    v_cvt_pk_bf16_f32 v96, v96, v97
    v_cvt_pk_bf16_f32 v97, v98, v99
    s_mov_b32 exec_lo, 0x00010001
    s_mov_b32 exec_hi, 0x00010001
    global_store_dwordx2 v13, v[96:97], s[38:39]
    s_mov_b64 exec, -1
    s_waitcnt vmcnt(0)
L_H2_JOIN:
L_FIN:
    s_endpgm
L_CHK_SLOW:
    s_mov_b32 s100, 20000
L_CHK_SLOW_LOOP:
    global_load_dword v138, v139, s[40:41] sc1
    s_sub_u32 s100, s100, 1
    s_cmp_eq_u32 s100, 0
    s_waitcnt vmcnt(0)
    s_cbranch_scc1 L_CHK_OK
    v_cmp_ne_u32 vcc, 8, v138
    s_cbranch_vccnz L_CHK_SLOW_LOOP
    s_branch L_CHK_OK
L_QCHK_SLOW:
    s_mov_b32 s100, 20000
L_QCHK_SLOW_LOOP:
    global_load_dword v14, v15, s[40:41] sc1
    s_sub_u32 s100, s100, 1
    s_cmp_eq_u32 s100, 0
    s_waitcnt vmcnt(0)
    s_cbranch_scc1 L_QCHK_OK
    v_cmp_ne_u32 vcc, 8, v14
    s_cbranch_vccnz L_QCHK_SLOW_LOOP
    s_branch L_QCHK_OK
L_HCHK_SLOW:
    s_mov_b32 s100, 20000
L_HCHK_SLOW_LOOP:
    global_load_dword v128, v129, s[40:41] sc1
    s_sub_u32 s100, s100, 1
    s_cmp_eq_u32 s100, 0
    s_waitcnt vmcnt(0)
    s_cbranch_scc1 L_HCHK_OK
    v_cmp_ne_u32 vcc, 4, v128
    s_cbranch_vccnz L_HCHK_SLOW_LOOP
    s_branch L_HCHK_OK
L_QPOLL_SLOW:
    s_mov_b32 s100, 20000
L_QPOLL_LOOP:
    global_load_dwordx4 v[48:51], v9, s[42:43] offset:0 sc1
    global_load_dwordx4 v[52:55], v9, s[42:43] offset:1024 sc1
    global_load_dwordx4 v[56:59], v9, s[42:43] offset:2048 sc1
    global_load_dwordx4 v[60:63], v9, s[42:43] offset:3072 sc1
    s_sub_u32 s100, s100, 1
    s_cmp_eq_u32 s100, 0
    s_waitcnt vmcnt(0)
    s_cbranch_scc1 L_QPOLL_OK
    v_max3_u32 v44, v48, v49, v50
    v_max3_u32 v45, v51, v52, v53
    v_max3_u32 v46, v54, v55, v56
    v_max3_u32 v47, v57, v58, v59
    v_max3_u32 v44, v44, v60, v61
    v_max3_u32 v45, v45, v62, v63
    v_max3_u32 v44, v44, v46, v47
    v_max_u32 v44, v44, v45
    v_cmp_eq_u32 vcc, -1, v44
    s_cbranch_vccnz L_QPOLL_LOOP
    s_branch L_QPOLL_OK
L_END:
s_endpgm
.section .rodata,"a"
.p2align 6
.amdhsa_kernel gated_mix__mha_block_cached__dense_activation_gelu__decode_kernel
  .amdhsa_next_free_vgpr 256
  .amdhsa_next_free_sgpr 102
  .amdhsa_accum_offset 256
  .amdhsa_group_segment_fixed_size 0
  .amdhsa_kernarg_size 112
  .amdhsa_user_sgpr_count 2
  .amdhsa_user_sgpr_kernarg_segment_ptr 1
  .amdhsa_system_sgpr_workgroup_id_x 1
.end_amdhsa_kernel
```
